```python
import torch

def _softmax(x, axis=-1):
    return torch.softmax(x, dim=axis)
def _gelu(x):
    return torch.nn.functional.gelu(x, approximate="tanh")
def _silu(x):
    return torch.nn.functional.silu(x)
def _sigmoid(x):
    return torch.sigmoid(x)
def _layernorm(x, axis=-1, eps=1e-5):
    m = x.mean(dim=axis, keepdim=True)
    v = x.var(dim=axis, keepdim=True, unbiased=False)
    return (x - m) / torch.sqrt(v + eps)
def _scatter_add(tgt, idx, src, axis=0):
    return tgt.clone().index_add_(axis, idx, src)
def _segment_sum(src, seg, n):
    out = torch.zeros((n,) + src.shape[1:], dtype=src.dtype)
    return out.index_add_(0, seg, src)
def _pad(x, pw):
    flat = tuple(v for pair in reversed(pw) for v in pair)
    return torch.nn.functional.pad(x, flat)

kernel_name = 'sequential_preLN__ssm_conv_h3__mixer_s_mlp__prompt'

def setup_inputs():

    _w = (lambda a: (lambda t: t.to(torch.bfloat16) if t.is_floating_point() else t)(torch.as_tensor(a)))
    def _A_setup():
        B, S, D = 1, 2048, 512
        ks = 4
        return {
            "q": _w((lambda *s: torch.randn(*s, dtype=torch.bfloat16) * 0.05)(B, S, D)),
            "k": _w((lambda *s: torch.randn(*s, dtype=torch.bfloat16) * 0.4)(B, S, D)),
            "v": _w((lambda *s: torch.randn(*s, dtype=torch.bfloat16) * 0.4)(B, S, D)),
            "shift_k": _w((lambda *s: torch.randn(*s, dtype=torch.bfloat16) * 0.4)(D, ks) * 0.5),
            "ssm_k": _w((lambda *s: torch.randn(*s, dtype=torch.bfloat16) * 0.4)(D, S) * (1.0 / S ** 0.5)),
            "ssm_D": _w((lambda *s: torch.randn(*s, dtype=torch.bfloat16) * 0.4)(D)),
        }
    _A_in = _A_setup()

    def _B_setup():
        B, S, D, F = 1, 2048, 512, 1376
        return {
            "x":  _w((lambda *s: torch.randn(*s, dtype=torch.bfloat16) * 0.05)(B, S, D)),
            "w1": _w((lambda *s: torch.randn(*s, dtype=torch.bfloat16) * 3.2)(D, D) * (D ** -0.5)),
            "w2": _w((lambda *s: torch.randn(*s, dtype=torch.bfloat16) * 3.2)(D, D) * (D ** -0.5)),
            "w3": _w((lambda *s: torch.randn(*s, dtype=torch.bfloat16) * 3.2)(D, F) * (D ** -0.5)),
            "w4": _w((lambda *s: torch.randn(*s, dtype=torch.bfloat16) * 1.6)(F, D) * (F ** -0.5)),
        }
    _B_in = _B_setup()

    return {
        "A_q": _A_in["q"],
        "A_k": _A_in["k"],
        "A_v": _A_in["v"],
        "A_shift_k": _A_in["shift_k"],
        "A_ssm_k": _A_in["ssm_k"],
        "A_ssm_D": _A_in["ssm_D"],
        "B_x": _B_in["x"],
        "B_w1": _B_in["w1"],
        "B_w2": _B_in["w2"],
        "B_w3": _B_in["w3"],
        "B_w4": _B_in["w4"],
    }

def reference(A_q, A_k, A_v, A_shift_k, A_ssm_k, A_ssm_D, B_x, B_w1, B_w2, B_w3, B_w4):
    def _A_ref(q, k, v, shift_k, ssm_k, ssm_D):
        B, S, D = q.shape
        ks = shift_k.shape[-1]
        k_pad = _pad(k, ((0, 0), (ks - 1, 0), (0, 0)))
        k_shift = torch.zeros_like(k)
        for t in range(ks):
            k_shift = k_shift + k_pad[:, t:t + S, :] * shift_k[:, ks - 1 - t][None, None, :]
        kv = k_shift * v
        L = 2 * S
        kv_pad = _pad(kv, ((0, 0), (0, S), (0, 0)))
        kf_pad = _pad(ssm_k, ((0, 0), (0, S)))
        kv_f = (lambda x, axes=(-2,-1): torch.fft.rfft2(x.float(), dim=axes))(kv_pad[:, None, :, :], axes=(1, 2))
        kf_f = (lambda x, axes=(-2,-1): torch.fft.rfft2(x.float(), dim=axes))(kf_pad[:, None, :], axes=(1, 2))
        kf_f = (lambda x, *d: x.permute(*d))(kf_f, 1, 2, 0)
        y_f = kv_f * kf_f[None, :, :, :]
        y = (lambda x, s, axes=(-2,-1): torch.fft.irfft2(x, s=s, dim=axes).to(torch.bfloat16))(y_f, (1, L), axes=(1, 2))[:, 0, :S, :]
        y = y + kv * ssm_D[None, None, :]
        return q * y

    def _B_ref(x, w1, w2, w3, w4):
        B, S, D = x.shape
        h = _gelu(_layernorm(x, axis=-1) @ w1)
        c = D // 4
        g0 = _pad(h[:, :, 0*c:1*c], ((0, 0), (1, 0), (0, 0)))[:, :S, :]
        g1 = _pad(h[:, :, 1*c:2*c], ((0, 0), (0, 1), (0, 0)))[:, 1:, :]
        g2 = _pad(h[:, :, 2*c:3*c], ((0, 0), (2, 0), (0, 0)))[:, :S, :]
        g3 = _pad(h[:, :, 3*c:   ], ((0, 0), (0, 2), (0, 0)))[:, 2:, :]
        hs = torch.concatenate([g0, g1, g2, g3], axis=-1) @ w2
        x1 = x + hs
        h2 = _gelu(_layernorm(x1, axis=-1) @ w3) @ w4
        return x1 + h2

    x = A_q
    h = x + _A_ref(_layernorm(x, axis=-1), A_k, A_v, A_shift_k, A_ssm_k, A_ssm_D)
    h2 = h + _B_ref(_layernorm(h, axis=-1), B_w1, B_w2, B_w3, B_w4)
    return h2
```

```asm
; @launch grid=(256,1,1) block=(256,1,1) lds=163840
.amdgcn_target "amdgcn-amd-amdhsa--gfx950"
.text
.globl sequential_preLN__ssm_conv_h3__mixer_s_mlp__prompt_kernel
.p2align 8
.type sequential_preLN__ssm_conv_h3__mixer_s_mlp__prompt_kernel,@function
sequential_preLN__ssm_conv_h3__mixer_s_mlp__prompt_kernel:
  s_cmp_ge_u32 s2, 256
  s_cbranch_scc1 Lend
  s_load_dwordx2 s[36:37], s[0:1], 8
  s_load_dwordx2 s[40:41], s[0:1], 16
  s_load_dwordx2 s[44:45], s[0:1], 0
  s_getpc_b64 s[84:85]
  s_lshr_b32 s49, s2, 3
  s_lshl_b32 s53, s49, 10
  v_lshlrev_b32 v7, 2, v0
  v_and_b32 v7, 0x380, v7
  v_add_u32 v7, s53, v7
  v_mov_b32 v9, s85
  v_add_co_u32 v8, vcc, s84, v7
  s_nop 1
  v_addc_co_u32 v9, vcc, 0, v9, vcc
  global_load_dword v148, v[8:9], off
  v_lshrrev_b32 v1, 6, v0
  s_nop 0
  v_readfirstlane_b32 s48, v1
  v_and_b32 v1, 63, v0
  s_mov_b32 s38, 0x200000
  s_mov_b32 s39, 0x20000
  s_mov_b32 s42, 0x200000
  s_mov_b32 s43, 0x20000
  s_mov_b32 s46, 0x200000
  s_mov_b32 s47, 0x20000
  v_lshrrev_b32 v7, 3, v1
  v_lshlrev_b32 v7, 10, v7
  v_and_b32 v8, 7, v1
  v_lshl_add_u32 v7, v8, 4, v7
  v_bfe_u32 v8, v1, 4, 1
  v_lshlrev_b32 v9, 5, v8
  v_xor_b32 v16, v9, v7
  v_xor_b32 v17, 64, v16
  v_add_u32 v18, 0x1c00, v17
  v_add_u32 v19, 0x1c00, v16
  s_and_b32 s50, s2, 7
  s_lshl_b32 s53, s49, 16
  s_lshl_b32 s54, s48, 14
  s_add_u32 s53, s53, s54
  s_lshl_b32 s54, s50, 7
  s_add_u32 s55, s53, s54
  s_lshl_b32 s56, s48, 11
  s_add_u32 s53, s56, 66560
  s_mov_b32 m0, s53
  s_waitcnt lgkmcnt(0)
  buffer_load_dwordx4 v17, s[36:39], s55 offen  lds
  buffer_load_dwordx4 v19, s[36:39], s55 offen offset:1024  lds
  s_add_u32 s53, s56, 74752
  s_mov_b32 m0, s53
  s_load_dwordx16 s[4:19], s[0:1], 0
  buffer_load_dwordx4 v16, s[40:43], s55 offen  lds
  buffer_load_dwordx4 v18, s[40:43], s55 offen offset:1024  lds
  s_add_u32 s53, s56, 82944
  s_mov_b32 m0, s53
  s_load_dwordx8 s[20:27], s[0:1], 64
  buffer_load_dwordx4 v16, s[44:47], s55 offen  lds
  buffer_load_dwordx4 v18, s[44:47], s55 offen offset:1024  lds
  s_load_dwordx4 s[28:31], s[0:1], 96
  s_memrealtime s[80:81]
  s_cmp_lg_u32 s48, 0
  s_cbranch_scc1 Lnoh
  s_sub_u32 s53, s55, 0x2000
  s_cselect_b32 s53, 0x400000, s53
  s_mov_b32 m0, 65536
  s_nop 0
  buffer_load_dwordx4 v16, s[36:39], s53 offen  lds
Lnoh:
  s_and_b32 s51, s48, 1
  s_lshr_b32 s52, s48, 1
  v_and_b32 v5, 15, v1
  v_lshrrev_b32 v6, 4, v1
  v_lshlrev_b32 v14, 4, v1
  v_lshlrev_b32 v9, 6, v8
  v_xor_b32 v184, v9, v7
  s_mov_b32 s60, 0x3b000000
  s_mov_b32 s61, 0xffff0000
  s_lshl_b32 s63, s2, 2
  s_add_u32 s63, s63, s48
  s_waitcnt lgkmcnt(0)
  s_cmp_lg_u32 s63, 0
  s_cbranch_scc1 Lnotag
  v_mov_b32 v2, s80
  v_mov_b32 v3, s81
  v_mov_b32 v4, 0
  s_mov_b64 exec, 1
  global_store_dwordx2 v4, v[2:3], s[28:29] sc1
  s_mov_b64 exec, -1
Lnotag:
  s_lshl_b32 s53, s50, 2
  s_add_u32 s53, s53, s48
  s_lshl_b32 s53, s53, 4
  v_add_u32 v20, s53, v5
  v_lshlrev_b32 v7, 3, v20
  global_load_dwordx2 v[44:45], v7, s[10:11]
  s_lshr_b32 s53, s2, 5
  s_lshl_b32 s53, s53, 18
  s_and_b32 s54, s63, 15
  s_lshl_b32 s54, s54, 14
  s_add_u32 s53, s53, s54
  s_bfe_u32 s54, s2, 0x20002
  s_lshl_b32 s54, s54, 12
  s_add_u32 s53, s53, s54
  s_bfe_u32 s54, s2, 0x10004
  s_lshl_b32 s54, s54, 11
  s_add_u32 s53, s53, s54
  v_add_u32 v7, s53, v14
  global_load_dwordx4 v[128:131], v7, s[4:5]
  global_load_dwordx4 v[132:135], v7, s[4:5] offset:1024
  s_lshl_b32 s64, s50, 6
  s_lshl_b32 s53, s49, 1
  s_add_u32 s64, s64, s53
  s_lshl_b32 s53, s64, 1
  s_load_dword s65, s[14:15], s53
  s_add_u32 s64, s64, s52
  s_lshl_b32 s66, s64, 12
  s_lshl_b32 s67, s51, 11
  v_add_u32 v10, s67, v14
  s_add_u32 s36, s12, s66
  s_addc_u32 s37, s13, 0
  s_mov_b32 s38, 0x1000
  s_mov_b32 s39, 0x20000
  v_add_u32 v150, -8, v10
  v_add_u32 v151, 1016, v10
  buffer_load_dwordx2 v[136:137], v150, s[36:39], 0 offen
  buffer_load_dwordx4 v[138:141], v10, s[36:39], 0 offen
  buffer_load_dwordx2 v[142:143], v151, s[36:39], 0 offen
  buffer_load_dwordx4 v[144:147], v10, s[36:39], 0 offen offset:1024
  s_mov_b32 s32, s30
  s_mov_b32 s33, s31
  s_mov_b32 s34, 0x10000000
  s_mov_b32 s35, 0x20000
  s_lshl_b32 s68, s50, 2
  s_and_b32 s53, s49, 3
  s_add_u32 s68, s68, s53
  s_lshl_b32 s53, s50, 9
  s_add_u32 s72, s53, 0x1450000
  s_lshl_b32 s54, s68, 8
  s_sub_u32 s54, s54, s53
  v_bfe_u32 v7, v1, 1, 3
  v_min_u32 v7, 4, v7
  v_cmp_ne_u32 vcc, 0, v7
  v_lshlrev_b32 v7, 13, v7
  v_and_b32 v8, 1, v1
  v_lshl_add_u32 v7, v8, 7, v7
  v_mov_b32 v8, s54
  v_cndmask_b32 v8, 0, v8, vcc
  v_add_u32 v7, v7, v8
  buffer_load_dword v149, v7, s[32:35], s72 offen sc1
  s_lshl_b32 s76, s48, 12
  s_add_u32 s76, s76, 98304
  s_sub_u32 s74, 1023, s63
  v_add_u32 v249, 7168, v184
  v_add_u32 v250, 14336, v184
  v_add_u32 v251, 21504, v184
  s_and_b32 s53, s63, 7
  s_mul_i32 s53, s53, 176128
  s_lshr_b32 s54, s63, 3
  s_lshl_b32 s54, s54, 11
  s_add_u32 s53, s53, s54
  s_add_u32 s53, s53, 0x1160000
  s_cmp_lt_u32 s63, 688
  s_cselect_b32 s88, s53, 0x10000000
  s_lshr_b32 s54, s74, 4
  s_lshl_b32 s54, s54, 15
  s_and_b32 s55, s74, 15
  s_lshl_b32 s55, s55, 10
  s_add_u32 s54, s54, s55
  s_add_u32 s54, s54, 0x1000000
  s_cmp_lt_u32 s74, 688
  s_cselect_b32 s89, s54, 0x10000000
  s_add_u32 s59, s89, 0x4000
  s_and_b32 s53, s49, 3
  s_lshr_b32 s69, s2, 5
  s_lshl_b32 s92, s53, 12
  s_lshl_b32 s77, s48, 14
  s_add_u32 s77, s77, 65536
  s_lshl_b32 s78, s48, 17
  s_lshl_b32 s53, s69, 7
  s_add_u32 s78, s78, s53
  s_mov_b32 s40, s20
  s_mov_b32 s41, s21
  s_mov_b32 s42, 0x80000
  s_mov_b32 s43, 0x20000
  s_mov_b32 s44, s18
  s_mov_b32 s45, s19
  s_mov_b32 s46, 0x80000
  s_mov_b32 s47, 0x20000
  s_and_b32 s86, s69, 3
  s_lshl_b32 s86, s86, 12
  v_mov_b32 v152, 0
  v_mov_b32 v153, 0
  v_mov_b32 v154, 0
  v_mov_b32 v155, 0
  s_mul_i32 s70, s52, 4608
  s_add_u32 s70, s70, 33280
  s_mul_i32 s71, s52, 16640
  v_and_b32 v7, 31, v1
  v_lshl_add_u32 v7, v7, 4, s70
  ds_write_b128 v7, v[152:155] offset:4096
  v_and_b32 v7, 1, v1
  v_lshlrev_b32 v7, 4, v7
  v_bfe_u32 v8, v1, 1, 2
  v_mul_u32_u24 v8, 4160, v8
  v_add3_u32 v7, v7, v8, s71
  ds_write_b128 v7, v[152:155] offset:0
  v_mov_b32 v252, -1
  v_mov_b32 v253, -1
  v_mov_b32 v254, -1
  v_mov_b32 v255, -1
  s_bfe_u32 s53, s69, 0x10001
  s_xor_b32 s53, s53, 1
  v_bfe_u32 v7, v1, 3, 1
  s_mul_i32 s54, s53, 31
  v_xor_b32 v7, s54, v7
  v_lshlrev_b32 v7, 4, v7
  v_and_b32 v8, 7, v1
  v_lshl_add_u32 v191, v8, 9, v7
  s_lshl_b32 s54, s68, 1
  s_add_u32 s53, s53, s54
  s_lshl_b32 s53, s53, 15
  s_lshl_b32 s54, s69, 12
  s_add_u32 s53, s53, s54
  s_add_u32 s79, s53, 0x600000
  v_and_b32 v11, 3, v5
  v_mul_u32_u24 v11, 4160, v11
  v_and_b32 v12, 12, v5
  v_lshl_add_u32 v11, v12, 1, v11
  v_lshl_add_u32 v11, v6, 4, v11
  s_lshl_b32 s56, s51, 8
  s_add_u32 s57, s56, s71
  s_add_u32 s57, s57, 8
  v_add_u32 v11, s57, v11
  v_lshlrev_b32 v12, 4, v6
  v_lshlrev_b32 v13, 5, v5
  v_sub_u32 v12, v12, v13
  s_add_u32 s57, s56, s70
  s_add_u32 s57, s57, 480
  v_add_u32 v12, s57, v12
  v_lshlrev_b32 v7, 4, v5
  v_lshl_add_u32 v7, v6, 2, v7
  s_lshl_b32 s56, s51, 10
  v_add_u32 v7, s56, v7
  v_lshlrev_b32 v8, 1, v7
  s_lshl_b32 s56, s51, 13
  v_add_u32 v9, s56, v14
  s_add_u32 s57, s70, 2552
  v_sub_u32 v13, s57, v8
  v_and_b32 v185, 1, v6
  v_lshlrev_b32 v185, 18, v185
  v_lshrrev_b32 v7, 2, v5
  v_lshl_add_u32 v185, v7, 16, v185
  v_and_b32 v7, 3, v5
  v_lshl_add_u32 v185, v7, 5, v185
  v_lshrrev_b32 v7, 1, v6
  v_lshl_add_u32 v185, v7, 4, v185
  v_lshrrev_b32 v21, 5, v1
  v_bfe_u32 v22, v1, 2, 2
  v_lshl_add_u32 v7, v21, 3, v22
  v_lshlrev_b32 v7, 7, v7
  v_lshrrev_b32 v23, 1, v22
  v_lshl_add_u32 v7, v23, 6, v7
  v_and_b32 v21, 1, v6
  v_lshl_add_u32 v7, v21, 5, v7
  v_and_b32 v24, 3, v1
  v_lshl_add_u32 v187, v24, 3, v7
  v_and_b32 v25, 1, v1
  v_lshl_add_u32 v7, v25, 4, v7
  v_bfe_u32 v25, v1, 1, 1
  v_lshl_add_u32 v188, v25, 3, v7
  v_add_u32 v189, s76, v188
  v_xor_b32 v190, 64, v189
  v_lshl_add_u32 v7, v6, 3, v22
  v_lshlrev_b32 v186, 6, v7
  v_lshl_add_u32 v186, v24, 3, v186
  v_add_u32 v186, s76, v186
  v_lshlrev_b32 v7, 7, v7
  v_lshl_add_u32 v23, v21, 1, v23
  v_xor_b32 v23, s48, v23
  v_lshl_add_u32 v7, v23, 5, v7
  v_lshl_add_u32 v7, v24, 3, v7
  v_add_u32 v26, 65536, v7
  v_xor_b32 v27, 64, v26
  v_lshlrev_b32 v20, 12, v20
  s_lshl_b32 s53, s49, 7
  v_lshl_add_u32 v7, v6, 4, s53
  v_add_u32 v28, v20, v7
  v_add_u32 v28, 0x200000, v28
  v_sub_u32 v29, v20, v7
  v_add_u32 v29, 4016, v29
  v_and_b32 v4, 31, v1
  v_lshlrev_b32 v4, 3, v4
  v_mov_b32 v0, 0
  s_waitcnt vmcnt(7)
  s_barrier
  global_load_dwordx2 v[2:3], v0, s[28:29] sc1
  ds_read_b64_tr_b16 v[30:31], v26 offset:512
  ds_read_b64_tr_b16 v[32:33], v27 offset:1024
  ds_read_b64_tr_b16 v[34:35], v27 offset:1536
  ds_read_b64_tr_b16 v[36:37], v26 offset:4608
  ds_read_b64_tr_b16 v[38:39], v27 offset:5120
  ds_read_b64_tr_b16 v[40:41], v27 offset:5632
  ds_read_b64_tr_b16 v[112:113], v26 offset:9216
  ds_read_b64_tr_b16 v[114:115], v26 offset:9728
  ds_read_b64_tr_b16 v[116:117], v26 offset:13312
  ds_read_b64_tr_b16 v[118:119], v26 offset:13824
  ds_read_b64_tr_b16 v[120:121], v26 offset:17408
  ds_read_b64_tr_b16 v[122:123], v26 offset:17920
  ds_read_b64_tr_b16 v[124:125], v26 offset:21504
  ds_read_b64_tr_b16 v[126:127], v26 offset:22016
  v_lshlrev_b32 v70, 16, v44
  v_and_b32 v71, s61, v44
  v_lshlrev_b32 v72, 16, v45
  v_and_b32 v73, s61, v45
  s_waitcnt lgkmcnt(8)
  v_and_b32 v48, s61, v30
  v_and_b32 v49, s61, v36
  v_lshlrev_b32 v50, 16, v31
  v_lshlrev_b32 v51, 16, v37
  v_and_b32 v52, s61, v31
  v_and_b32 v53, s61, v37
  v_lshlrev_b32 v54, 16, v32
  v_lshlrev_b32 v55, 16, v38
  v_and_b32 v56, s61, v32
  v_and_b32 v57, s61, v38
  v_lshlrev_b32 v58, 16, v33
  v_lshlrev_b32 v59, 16, v39
  v_and_b32 v60, s61, v33
  v_and_b32 v61, s61, v39
  v_lshlrev_b32 v62, 16, v34
  v_lshlrev_b32 v63, 16, v40
  v_and_b32 v64, s61, v34
  v_and_b32 v65, s61, v40
  v_lshlrev_b32 v66, 16, v35
  v_lshlrev_b32 v67, 16, v41
  v_and_b32 v68, s61, v35
  v_and_b32 v69, s61, v41
  s_waitcnt lgkmcnt(0)
  buffer_store_dwordx4 v[120:123], v28, s[32:35], 0 offen sc1
  buffer_store_dwordx4 v[124:127], v28, s[32:35], 0 offen offset:64 sc1
  v_pk_mul_f32 v[94:95], v[48:49], v[72:73] op_sel:[0,1] op_sel_hi:[1,1]
  v_pk_mul_f32 v[96:97], v[50:51], v[72:73] op_sel:[0,1] op_sel_hi:[1,1]
  v_pk_mul_f32 v[98:99], v[52:53], v[72:73] op_sel:[0,1] op_sel_hi:[1,1]
  v_pk_mul_f32 v[100:101], v[54:55], v[72:73] op_sel:[0,1] op_sel_hi:[1,1]
  v_pk_mul_f32 v[102:103], v[56:57], v[72:73] op_sel:[0,1] op_sel_hi:[1,1]
  v_pk_mul_f32 v[104:105], v[58:59], v[72:73] op_sel:[0,1] op_sel_hi:[1,1]
  v_pk_mul_f32 v[106:107], v[60:61], v[72:73] op_sel:[0,1] op_sel_hi:[1,1]
  v_pk_mul_f32 v[108:109], v[62:63], v[72:73] op_sel:[0,1] op_sel_hi:[1,1]
  v_pk_fma_f32 v[94:95], v[50:51], v[72:73], v[94:95] op_sel:[0,0,0] op_sel_hi:[1,0,1]
  v_pk_fma_f32 v[96:97], v[52:53], v[72:73], v[96:97] op_sel:[0,0,0] op_sel_hi:[1,0,1]
  v_pk_fma_f32 v[98:99], v[54:55], v[72:73], v[98:99] op_sel:[0,0,0] op_sel_hi:[1,0,1]
  v_pk_fma_f32 v[100:101], v[56:57], v[72:73], v[100:101] op_sel:[0,0,0] op_sel_hi:[1,0,1]
  v_pk_fma_f32 v[102:103], v[58:59], v[72:73], v[102:103] op_sel:[0,0,0] op_sel_hi:[1,0,1]
  v_pk_fma_f32 v[104:105], v[60:61], v[72:73], v[104:105] op_sel:[0,0,0] op_sel_hi:[1,0,1]
  v_pk_fma_f32 v[106:107], v[62:63], v[72:73], v[106:107] op_sel:[0,0,0] op_sel_hi:[1,0,1]
  v_pk_fma_f32 v[108:109], v[64:65], v[72:73], v[108:109] op_sel:[0,0,0] op_sel_hi:[1,0,1]
  v_pk_fma_f32 v[94:95], v[52:53], v[70:71], v[94:95] op_sel:[0,1,0] op_sel_hi:[1,1,1]
  v_pk_fma_f32 v[96:97], v[54:55], v[70:71], v[96:97] op_sel:[0,1,0] op_sel_hi:[1,1,1]
  v_pk_fma_f32 v[98:99], v[56:57], v[70:71], v[98:99] op_sel:[0,1,0] op_sel_hi:[1,1,1]
  v_pk_fma_f32 v[100:101], v[58:59], v[70:71], v[100:101] op_sel:[0,1,0] op_sel_hi:[1,1,1]
  v_pk_fma_f32 v[102:103], v[60:61], v[70:71], v[102:103] op_sel:[0,1,0] op_sel_hi:[1,1,1]
  v_pk_fma_f32 v[104:105], v[62:63], v[70:71], v[104:105] op_sel:[0,1,0] op_sel_hi:[1,1,1]
  v_pk_fma_f32 v[106:107], v[64:65], v[70:71], v[106:107] op_sel:[0,1,0] op_sel_hi:[1,1,1]
  v_pk_fma_f32 v[108:109], v[66:67], v[70:71], v[108:109] op_sel:[0,1,0] op_sel_hi:[1,1,1]
  v_pk_fma_f32 v[94:95], v[54:55], v[70:71], v[94:95] op_sel:[0,0,0] op_sel_hi:[1,0,1]
  v_pk_fma_f32 v[96:97], v[56:57], v[70:71], v[96:97] op_sel:[0,0,0] op_sel_hi:[1,0,1]
  v_pk_fma_f32 v[98:99], v[58:59], v[70:71], v[98:99] op_sel:[0,0,0] op_sel_hi:[1,0,1]
  v_pk_fma_f32 v[100:101], v[60:61], v[70:71], v[100:101] op_sel:[0,0,0] op_sel_hi:[1,0,1]
  v_pk_fma_f32 v[102:103], v[62:63], v[70:71], v[102:103] op_sel:[0,0,0] op_sel_hi:[1,0,1]
  v_pk_fma_f32 v[104:105], v[64:65], v[70:71], v[104:105] op_sel:[0,0,0] op_sel_hi:[1,0,1]
  v_pk_fma_f32 v[106:107], v[66:67], v[70:71], v[106:107] op_sel:[0,0,0] op_sel_hi:[1,0,1]
  v_pk_fma_f32 v[108:109], v[68:69], v[70:71], v[108:109] op_sel:[0,0,0] op_sel_hi:[1,0,1]
  v_lshlrev_b32 v78, 16, v112
  v_lshlrev_b32 v79, 16, v116
  v_and_b32 v80, s61, v112
  v_and_b32 v81, s61, v116
  v_lshlrev_b32 v82, 16, v113
  v_lshlrev_b32 v83, 16, v117
  v_and_b32 v84, s61, v113
  v_and_b32 v85, s61, v117
  v_lshlrev_b32 v86, 16, v114
  v_lshlrev_b32 v87, 16, v118
  v_and_b32 v88, s61, v114
  v_and_b32 v89, s61, v118
  v_lshlrev_b32 v90, 16, v115
  v_lshlrev_b32 v91, 16, v119
  v_and_b32 v92, s61, v115
  v_and_b32 v93, s61, v119
  v_pk_mul_f32 v[94:95], v[94:95], v[78:79]
  v_pk_mul_f32 v[96:97], v[96:97], v[80:81]
  v_pk_mul_f32 v[98:99], v[98:99], v[82:83]
  v_pk_mul_f32 v[100:101], v[100:101], v[84:85]
  v_pk_mul_f32 v[102:103], v[102:103], v[86:87]
  v_pk_mul_f32 v[104:105], v[104:105], v[88:89]
  v_pk_mul_f32 v[106:107], v[106:107], v[90:91]
  v_pk_mul_f32 v[108:109], v[108:109], v[92:93]
  v_cvt_pk_bf16_f32 v112, v108, v106
  v_cvt_pk_bf16_f32 v113, v104, v102
  v_cvt_pk_bf16_f32 v114, v100, v98
  v_cvt_pk_bf16_f32 v115, v96, v94
  v_cvt_pk_bf16_f32 v116, v109, v107
  v_cvt_pk_bf16_f32 v117, v105, v103
  v_cvt_pk_bf16_f32 v118, v101, v99
  v_cvt_pk_bf16_f32 v119, v97, v95
  buffer_store_dwordx4 v[112:115], v29, s[32:35], 0 offen offset:64 sc1
  buffer_store_dwordx4 v[116:119], v29, s[32:35], 0 offen sc1
  s_mov_b32 s36, s24
  s_mov_b32 s37, s25
  s_mov_b32 s38, 0x158000
  s_mov_b32 s39, 0x20000
  s_and_b32 s53, s63, 7
  s_lshl_b32 s53, s53, 7
  s_lshr_b32 s54, s63, 3
  s_lshl_b32 s54, s54, 14
  s_add_u32 s73, s53, s54
  s_mov_b32 m0, s76
  s_nop 0
  buffer_load_dwordx4 v184, s[36:39], s73 offen  lds
  buffer_load_dwordx4 v249, s[36:39], s73 offen offset:1024  lds
  s_mov_b32 s36, s22
  s_mov_b32 s37, s23
  s_mov_b32 s38, 0x158000
  s_mov_b32 s39, 0x20000
  s_and_b32 s53, s74, 15
  s_mul_i32 s53, s53, 88064
  s_lshr_b32 s54, s74, 4
  s_lshl_b32 s54, s54, 6
  s_add_u32 s75, s53, s54
  s_cmp_lt_u32 s74, 688
  s_cselect_b32 s75, s75, 0x400000
  v_lshrrev_b32 v150, 2, v1
  v_mul_u32_u24 v150, 2752, v150
  v_and_b32 v151, 3, v1
  v_lshl_add_u32 v150, v151, 4, v150
  s_add_u32 s53, s76, 2048
  s_mov_b32 m0, s53
  s_add_u32 s54, s75, 43008
  buffer_load_dwordx4 v150, s[36:39], s75 offen  lds
  buffer_load_dwordx4 v150, s[36:39], s54 offen offset:1024  lds
  s_waitcnt vmcnt(14)
  v_lshlrev_b32 v48, 16, v128
  v_and_b32 v49, s61, v128
  v_lshlrev_b32 v50, 16, v129
  v_and_b32 v51, s61, v129
  v_lshlrev_b32 v52, 16, v130
  v_and_b32 v53, s61, v130
  v_lshlrev_b32 v54, 16, v131
  v_and_b32 v55, s61, v131
  v_lshlrev_b32 v56, 16, v132
  v_and_b32 v57, s61, v132
  v_lshlrev_b32 v58, 16, v133
  v_and_b32 v59, s61, v133
  v_lshlrev_b32 v60, 16, v134
  v_and_b32 v61, s61, v134
  v_lshlrev_b32 v62, 16, v135
  v_and_b32 v63, s61, v135
  v_pk_add_f32 v[70:71], v[48:49], v[50:51]
  v_pk_add_f32 v[74:75], v[52:53], v[54:55]
  v_pk_add_f32 v[72:73], v[56:57], v[58:59]
  v_pk_add_f32 v[76:77], v[60:61], v[62:63]
  v_pk_add_f32 v[70:71], v[70:71], v[74:75]
  v_pk_add_f32 v[72:73], v[72:73], v[76:77]
  v_add_f32 v64, v70, v71
  v_add_f32 v65, v72, v73
  s_nop 0
  v_add_f32_dpp v64, v64, v64 quad_perm:[1,0,3,2] row_mask:0xf bank_mask:0xf
  v_add_f32_dpp v65, v65, v65 quad_perm:[1,0,3,2] row_mask:0xf bank_mask:0xf
  s_nop 0
  v_add_f32_dpp v64, v64, v64 quad_perm:[2,3,0,1] row_mask:0xf bank_mask:0xf
  v_add_f32_dpp v65, v65, v65 quad_perm:[2,3,0,1] row_mask:0xf bank_mask:0xf
  s_nop 0
  v_add_f32_dpp v64, v64, v64 row_half_mirror row_mask:0xf bank_mask:0xf
  v_add_f32_dpp v65, v65, v65 row_half_mirror row_mask:0xf bank_mask:0xf
  s_nop 0
  v_add_f32_dpp v64, v64, v64 row_mirror row_mask:0xf bank_mask:0xf
  v_add_f32_dpp v65, v65, v65 row_mirror row_mask:0xf bank_mask:0xf
  v_mov_b32 v66, v64
  v_mov_b32 v67, v65
  s_nop 0
  v_permlane16_swap_b32 v64, v66
  v_permlane16_swap_b32 v65, v67
  v_add_f32 v64, v64, v66
  v_add_f32 v65, v65, v67
  v_mov_b32 v66, v64
  v_mov_b32 v67, v65
  s_nop 0
  v_permlane32_swap_b32 v64, v66
  v_permlane32_swap_b32 v65, v67
  v_add_f32 v64, v64, v66
  v_add_f32 v65, v65, v67
  v_mul_f32 v64, s60, v64
  v_mul_f32 v65, s60, v65
  v_pk_add_f32 v[48:49], v[48:49], v[64:65] op_sel:[0,0] op_sel_hi:[1,0] neg_lo:[0,1] neg_hi:[0,1]
  v_pk_add_f32 v[50:51], v[50:51], v[64:65] op_sel:[0,0] op_sel_hi:[1,0] neg_lo:[0,1] neg_hi:[0,1]
  v_pk_add_f32 v[52:53], v[52:53], v[64:65] op_sel:[0,0] op_sel_hi:[1,0] neg_lo:[0,1] neg_hi:[0,1]
  v_pk_add_f32 v[54:55], v[54:55], v[64:65] op_sel:[0,0] op_sel_hi:[1,0] neg_lo:[0,1] neg_hi:[0,1]
  v_pk_add_f32 v[56:57], v[56:57], v[64:65] op_sel:[0,1] op_sel_hi:[1,1] neg_lo:[0,1] neg_hi:[0,1]
  v_pk_add_f32 v[58:59], v[58:59], v[64:65] op_sel:[0,1] op_sel_hi:[1,1] neg_lo:[0,1] neg_hi:[0,1]
  v_pk_add_f32 v[60:61], v[60:61], v[64:65] op_sel:[0,1] op_sel_hi:[1,1] neg_lo:[0,1] neg_hi:[0,1]
  v_pk_add_f32 v[62:63], v[62:63], v[64:65] op_sel:[0,1] op_sel_hi:[1,1] neg_lo:[0,1] neg_hi:[0,1]
  v_pk_mul_f32 v[70:71], v[48:49], v[48:49]
  v_pk_fma_f32 v[70:71], v[50:51], v[50:51], v[70:71]
  v_pk_fma_f32 v[70:71], v[52:53], v[52:53], v[70:71]
  v_pk_fma_f32 v[70:71], v[54:55], v[54:55], v[70:71]
  v_pk_mul_f32 v[72:73], v[56:57], v[56:57]
  v_pk_fma_f32 v[72:73], v[58:59], v[58:59], v[72:73]
  v_pk_fma_f32 v[72:73], v[60:61], v[60:61], v[72:73]
  v_pk_fma_f32 v[72:73], v[62:63], v[62:63], v[72:73]
  v_add_f32 v68, v70, v71
  v_add_f32 v69, v72, v73
  s_nop 0
  v_add_f32_dpp v68, v68, v68 quad_perm:[1,0,3,2] row_mask:0xf bank_mask:0xf
  v_add_f32_dpp v69, v69, v69 quad_perm:[1,0,3,2] row_mask:0xf bank_mask:0xf
  s_nop 0
  v_add_f32_dpp v68, v68, v68 quad_perm:[2,3,0,1] row_mask:0xf bank_mask:0xf
  v_add_f32_dpp v69, v69, v69 quad_perm:[2,3,0,1] row_mask:0xf bank_mask:0xf
  s_nop 0
  v_add_f32_dpp v68, v68, v68 row_half_mirror row_mask:0xf bank_mask:0xf
  v_add_f32_dpp v69, v69, v69 row_half_mirror row_mask:0xf bank_mask:0xf
  s_nop 0
  v_add_f32_dpp v68, v68, v68 row_mirror row_mask:0xf bank_mask:0xf
  v_add_f32_dpp v69, v69, v69 row_mirror row_mask:0xf bank_mask:0xf
  v_mov_b32 v66, v68
  v_mov_b32 v67, v69
  s_nop 0
  v_permlane16_swap_b32 v68, v66
  v_permlane16_swap_b32 v69, v67
  v_add_f32 v68, v68, v66
  v_add_f32 v69, v69, v67
  v_mov_b32 v66, v68
  v_mov_b32 v67, v69
  s_nop 0
  v_permlane32_swap_b32 v68, v66
  v_permlane32_swap_b32 v69, v67
  v_add_f32 v68, v68, v66
  v_add_f32 v69, v69, v67
  v_mul_f32 v68, s60, v68
  v_mul_f32 v69, s60, v69
  v_cvt_pk_bf16_f32 v68, v68, v69
  v_and_b32 v69, s61, v68
  v_lshlrev_b32 v68, 16, v68
  v_add_f32 v68, 0x3727c5ac, v68
  v_add_f32 v69, 0x3727c5ac, v69
  v_cvt_pk_bf16_f32 v68, v68, v69
  v_and_b32 v69, s61, v68
  v_lshlrev_b32 v68, 16, v68
  v_sqrt_f32 v68, v68
  v_sqrt_f32 v69, v69
  s_lshl_b32 s53, s48, 3
  s_add_u32 s53, s53, 42496
  v_mov_b32 v7, s53
  v_cvt_pk_bf16_f32 v72, v68, v64
  v_cvt_pk_bf16_f32 v73, v69, v65
  ds_write_b64 v7, v[72:73]
  s_lshl_b32 s53, s49, 3
  s_add_u32 s87, s53, s72
  s_mov_b32 s82, 0
  s_waitcnt vmcnt(4) lgkmcnt(0)
Ltag:
  v_readfirstlane_b32 s80, v2
  v_readfirstlane_b32 s81, v3
  s_nop 0
  s_or_b32 s53, s80, s81
  s_cbranch_scc1 Ltagok
  global_load_dwordx2 v[2:3], v0, s[28:29] sc1
  s_add_u32 s82, s82, 1
  s_cmp_gt_u32 s82, 0x20000
  s_cbranch_scc1 Lend
  s_waitcnt vmcnt(0)
  s_branch Ltag
Ltagok:
  s_barrier
  s_cmp_lg_u32 s48, 0
  s_cbranch_scc1 Lsig0
  s_mov_b64 exec, 1
  buffer_store_dwordx2 v[2:3], off, s[32:35], s87
  s_add_u32 s83, s87, 0x10000
  buffer_store_dwordx2 v[2:3], off, s[32:35], s83 sc1
  s_mov_b64 exec, -1
Lsig0:
  s_cmp_lg_u32 s48, 1
  s_cbranch_scc1 Lnost
  v_lshlrev_b32 v7, 3, v1
  ds_read_b64 v[72:73], v7 offset:42496
  s_lshl_b32 s53, s2, 6
  s_add_u32 s53, s53, 0x1400000
  v_mov_b32 v75, s80
  s_mov_b64 exec, 15
  s_waitcnt lgkmcnt(0)
  v_mov_b32 v74, v73
  v_mov_b32 v73, s80
  buffer_store_dwordx4 v[72:75], v14, s[32:35], s53 offen sc1
  s_mov_b64 exec, -1
Lnost:
  v_add_u32 v7, s71, v10
  v_alignbit_b32 v20, v137, v136, 16
  v_alignbit_b32 v21, v138, v137, 16
  v_alignbit_b32 v22, v139, v138, 16
  v_alignbit_b32 v23, v140, v139, 16
  v_mov_b32 v24, v137
  v_mov_b32 v25, v138
  v_mov_b32 v26, v139
  v_mov_b32 v27, v140
  v_alignbit_b32 v28, v138, v137, 16
  v_alignbit_b32 v29, v139, v138, 16
  v_alignbit_b32 v30, v140, v139, 16
  v_alignbit_b32 v31, v141, v140, 16
  ds_write_b128 v7, v[138:141] offset:12512
  ds_write_b128 v7, v[20:23] offset:32
  ds_write_b128 v7, v[24:27] offset:4192
  ds_write_b128 v7, v[28:31] offset:8352
  v_alignbit_b32 v32, v143, v142, 16
  v_alignbit_b32 v33, v144, v143, 16
  v_alignbit_b32 v34, v145, v144, 16
  v_alignbit_b32 v35, v146, v145, 16
  v_mov_b32 v36, v143
  v_mov_b32 v37, v144
  v_mov_b32 v38, v145
  v_mov_b32 v39, v146
  v_alignbit_b32 v40, v144, v143, 16
  v_alignbit_b32 v41, v145, v144, 16
  v_alignbit_b32 v42, v146, v145, 16
  v_alignbit_b32 v43, v147, v146, 16
  ds_write_b128 v7, v[144:147] offset:13536
  ds_write_b128 v7, v[32:35] offset:1056
  ds_write_b128 v7, v[36:39] offset:5216
  ds_write_b128 v7, v[40:43] offset:9376
  s_add_u32 s56, s70, s67
  s_mov_b32 m0, s56
  s_add_u32 s57, s66, 0
  s_add_u32 s58, s66, 0x200000
  s_mov_b32 s82, 0
  buffer_load_dwordx2 v[16:17], v4, s[32:35], s72 offen sc1
Lpoll1:
  s_waitcnt vmcnt(0)
  v_cmp_ne_u64 vcc, s[80:81], v[16:17]
  s_cbranch_vccz Lpolld1
  s_cmp_lg_u32 s82, 32
  s_cbranch_scc1 Lpollp1
  s_add_u32 s83, s87, 0x10000
  s_mov_b64 exec, 1
  buffer_store_dwordx2 v[2:3], off, s[32:35], s83 sc1
  s_mov_b64 exec, -1
Lpollp1:
  s_cmp_lt_u32 s82, 32
  s_cselect_b32 s83, 0, 0x10000
  s_add_u32 s83, s83, s72
  buffer_load_dwordx2 v[16:17], v4, s[32:35], s83 offen sc1
  s_add_u32 s82, s82, 1
  s_cmp_gt_u32 s82, 0x20000
  s_cbranch_scc1 Lend
  s_branch Lpoll1
Lpolld1:
  buffer_load_dwordx4 v10, s[32:35], s57 offen sc1 lds
  buffer_load_dwordx4 v10, s[32:35], s57 offen offset:1024 sc1 lds
  buffer_load_dwordx2 v[208:209], v8, s[32:35], s58 offen offset:0 sc1
  buffer_load_dwordx2 v[210:211], v8, s[32:35], s58 offen offset:512 sc1
  buffer_load_dwordx2 v[212:213], v8, s[32:35], s58 offen offset:1024 sc1
  buffer_load_dwordx2 v[214:215], v8, s[32:35], s58 offen offset:1536 sc1
  ds_read_b64_tr_b16 v[192:193], v189 offset:0
  ds_read_b64_tr_b16 v[194:195], v189 offset:512
  ds_read_b64_tr_b16 v[196:197], v190 offset:0
  ds_read_b64_tr_b16 v[198:199], v190 offset:512
  ds_read_b64_tr_b16 v[200:201], v186 offset:2048
  ds_read_b64_tr_b16 v[202:203], v186 offset:2304
  ds_read_b64_tr_b16 v[204:205], v186 offset:2080
  ds_read_b64_tr_b16 v[206:207], v186 offset:2336
  s_waitcnt lgkmcnt(0)
  s_barrier
  s_lshl_b32 s56, s65, 16
  s_and_b32 s57, s65, 0xffff0000
  s_cmp_eq_u32 s52, 0
  s_cselect_b32 s65, s56, s57
  s_lshl_b32 s57, s51, 20
  s_lshl_b32 s58, s64, 7
  s_add_u32 s57, s57, s58
  s_add_u32 s57, s57, 0x400000
  s_add_u32 s58, s57, 0x80000
  s_lshl_b32 s53, s48, 12
  s_add_u32 s53, s53, 42496
  v_add_u32 v190, s53, v14
  v_xor_b32 v189, 0x1000, v14
  s_lshl_b32 s53, s48, 12
  v_xor_b32 v189, s53, v189
  v_add_u32 v189, 42496, v189
  ds_read_b64 v[48:49], v11 offset:0
  ds_read_b64 v[50:51], v11 offset:8
  ds_read_b64 v[52:53], v11 offset:512
  ds_read_b64 v[54:55], v11 offset:520
  ds_read_b64 v[56:57], v11 offset:1024
  ds_read_b64 v[58:59], v11 offset:1032
  ds_read_b64 v[60:61], v11 offset:1536
  ds_read_b64 v[62:63], v11 offset:1544
  ds_read_b64 v[64:65], v11 offset:2048
  ds_read_b64 v[66:67], v11 offset:2056
  ds_read_b64 v[68:69], v11 offset:2560
  ds_read_b64 v[70:71], v11 offset:2568
  ds_read_b64 v[72:73], v11 offset:3072
  ds_read_b64 v[74:75], v11 offset:3080
  ds_read_b64 v[76:77], v11 offset:3584
  ds_read_b64 v[78:79], v11 offset:3592
  s_waitcnt vmcnt(4)
  s_barrier
  ds_read_b128 v[80:83], v12 offset:3584
  ds_read_b128 v[84:87], v12 offset:3072
  ds_read_b128 v[88:91], v12 offset:2560
  ds_read_b128 v[92:95], v12 offset:2048
  ds_read_b128 v[96:99], v12 offset:1536
  ds_read_b128 v[100:103], v12 offset:1024
  ds_read_b128 v[104:107], v12 offset:512
  ds_read_b128 v[108:111], v12 offset:0
  s_waitcnt lgkmcnt(7)
  v_mfma_f32_16x16x32_bf16 v[16:19], v[48:51], v[80:83], 0
  s_waitcnt lgkmcnt(6)
  v_mfma_f32_16x16x32_bf16 v[20:23], v[52:55], v[80:83], 0
  v_mfma_f32_16x16x32_bf16 v[24:27], v[52:55], v[84:87], 0
  s_mov_b32 s54, 0x1400000
  buffer_load_dwordx4 v[216:219], v9, s[32:35], s54 offen offset:0
  v_mfma_f32_16x16x32_bf16 v[20:23], v[48:51], v[84:87], v[20:23]
  s_waitcnt lgkmcnt(5)
  v_mfma_f32_16x16x32_bf16 v[24:27], v[56:59], v[80:83], v[24:27]
  ds_read_b64 v[112:113], v11 offset:64
  v_mfma_f32_16x16x32_bf16 v[28:31], v[56:59], v[84:87], 0
  ds_read_b64 v[114:115], v11 offset:72
  s_mov_b32 s54, 0x1400000
  buffer_load_dwordx4 v[220:223], v9, s[32:35], s54 offen offset:1024
  v_mfma_f32_16x16x32_bf16 v[32:35], v[56:59], v[88:91], 0
  ds_read_b128 v[144:147], v12 offset:3648
  v_mfma_f32_16x16x32_bf16 v[24:27], v[48:51], v[88:91], v[24:27]
  ds_read_b64 v[116:117], v11 offset:576
  v_mfma_f32_16x16x32_bf16 v[28:31], v[52:55], v[88:91], v[28:31]
  ds_read_b64 v[118:119], v11 offset:584
  s_mov_b32 s54, 0x1400000
  buffer_load_dwordx4 v[224:227], v9, s[32:35], s54 offen offset:2048
  s_waitcnt lgkmcnt(9)
  v_mfma_f32_16x16x32_bf16 v[28:31], v[60:63], v[80:83], v[28:31]
  ds_read_b128 v[148:151], v12 offset:3136
  v_mfma_f32_16x16x32_bf16 v[32:35], v[60:63], v[84:87], v[32:35]
  ds_read_b64 v[120:121], v11 offset:1088
  v_mfma_f32_16x16x32_bf16 v[36:39], v[60:63], v[88:91], 0
  ds_read_b64 v[122:123], v11 offset:1096
  s_mov_b32 s54, 0x1400000
  buffer_load_dwordx4 v[228:231], v9, s[32:35], s54 offen offset:3072
  v_mfma_f32_16x16x32_bf16 v[40:43], v[60:63], v[92:95], 0
  ds_read_b128 v[152:155], v12 offset:2624
  v_mfma_f32_16x16x32_bf16 v[28:31], v[48:51], v[92:95], v[28:31]
  ds_read_b64 v[124:125], v11 offset:1600
  v_mfma_f32_16x16x32_bf16 v[32:35], v[52:55], v[92:95], v[32:35]
  ds_read_b64 v[126:127], v11 offset:1608
  s_mov_b32 s54, 0x1401000
  buffer_load_dwordx4 v[232:235], v9, s[32:35], s54 offen offset:0
  v_mfma_f32_16x16x32_bf16 v[36:39], v[56:59], v[92:95], v[36:39]
  ds_read_b128 v[156:159], v12 offset:2112
  s_waitcnt lgkmcnt(15)
  v_mfma_f32_16x16x32_bf16 v[32:35], v[64:67], v[80:83], v[32:35]
  ds_read_b64 v[128:129], v11 offset:2112
  v_mfma_f32_16x16x32_bf16 v[36:39], v[64:67], v[84:87], v[36:39]
  ds_read_b64 v[130:131], v11 offset:2120
  s_mov_b32 s54, 0x1401000
  buffer_load_dwordx4 v[236:239], v9, s[32:35], s54 offen offset:1024
  v_mfma_f32_16x16x32_bf16 v[40:43], v[64:67], v[88:91], v[40:43]
  ds_read_b128 v[160:163], v12 offset:1600
  v_mfma_f32_16x16x32_bf16 v[44:47], v[64:67], v[92:95], 0
  ds_read_b64 v[132:133], v11 offset:2624
  v_mfma_f32_16x16x32_bf16 v[32:35], v[48:51], v[96:99], v[32:35]
  ds_read_b64 v[134:135], v11 offset:2632
  s_mov_b32 s54, 0x1401000
  buffer_load_dwordx4 v[240:243], v9, s[32:35], s54 offen offset:2048
  v_mfma_f32_16x16x32_bf16 v[36:39], v[52:55], v[96:99], v[36:39]
  ds_read_b128 v[164:167], v12 offset:1088
  v_mfma_f32_16x16x32_bf16 v[40:43], v[56:59], v[96:99], v[40:43]
  ds_read_b64 v[136:137], v11 offset:3136
  v_mfma_f32_16x16x32_bf16 v[44:47], v[60:63], v[96:99], v[44:47]
  ds_read_b64 v[138:139], v11 offset:3144
  s_mov_b32 s54, 0x1401000
  buffer_load_dwordx4 v[244:247], v9, s[32:35], s54 offen offset:3072
  s_waitcnt lgkmcnt(15)
  v_mfma_f32_16x16x32_bf16 v[36:39], v[68:71], v[80:83], v[36:39]
  ds_read_b128 v[168:171], v12 offset:576
  v_mfma_f32_16x16x32_bf16 v[40:43], v[68:71], v[84:87], v[40:43]
  ds_read_b64 v[140:141], v11 offset:3648
  v_mfma_f32_16x16x32_bf16 v[44:47], v[68:71], v[88:91], v[44:47]
  ds_read_b64 v[142:143], v11 offset:3656
  v_mfma_f32_16x16x32_bf16 v[36:39], v[48:51], v[100:103], v[36:39]
  ds_read_b128 v[172:175], v12 offset:64
  v_mfma_f32_16x16x32_bf16 v[40:43], v[52:55], v[100:103], v[40:43]
  v_mfma_f32_16x16x32_bf16 v[44:47], v[56:59], v[100:103], v[44:47]
  s_add_u32 s55, s92, 0
  s_and_b32 s55, s55, 0x3fff
  s_add_u32 s53, s77, s55
  s_mov_b32 m0, s53
  s_xor_b32 s55, s55, s86
  s_lshl_b32 s55, s55, 3
  s_add_u32 s93, s78, s55
  buffer_load_dwordx4 v184, s[44:47], s93 offen offset:0 lds
  s_waitcnt lgkmcnt(15)
  v_mfma_f32_16x16x32_bf16 v[40:43], v[72:75], v[80:83], v[40:43]
  v_mfma_f32_16x16x32_bf16 v[44:47], v[72:75], v[84:87], v[44:47]
  v_mfma_f32_16x16x32_bf16 v[40:43], v[48:51], v[104:107], v[40:43]
  v_mfma_f32_16x16x32_bf16 v[44:47], v[52:55], v[104:107], v[44:47]
  s_waitcnt lgkmcnt(15)
  v_mfma_f32_16x16x32_bf16 v[44:47], v[76:79], v[80:83], v[44:47]
  v_mfma_f32_16x16x32_bf16 v[44:47], v[48:51], v[108:111], v[44:47]
  buffer_load_dwordx4 v249, s[44:47], s93 offen offset:1024 lds
  s_waitcnt lgkmcnt(0)
  v_mfma_f32_16x16x32_bf16 v[16:19], v[112:115], v[144:147], v[16:19]
  ds_read_b64 v[48:49], v11 offset:128
  v_mfma_f32_16x16x32_bf16 v[20:23], v[116:119], v[144:147], v[20:23]
  ds_read_b64 v[50:51], v11 offset:136
  v_mfma_f32_16x16x32_bf16 v[24:27], v[116:119], v[148:151], v[24:27]
  ds_read_b128 v[80:83], v12 offset:3712
  v_mfma_f32_16x16x32_bf16 v[20:23], v[112:115], v[148:151], v[20:23]
  ds_read_b64 v[52:53], v11 offset:640
  v_mfma_f32_16x16x32_bf16 v[24:27], v[120:123], v[144:147], v[24:27]
  ds_read_b64 v[54:55], v11 offset:648
  v_mfma_f32_16x16x32_bf16 v[28:31], v[120:123], v[148:151], v[28:31]
  ds_read_b128 v[84:87], v12 offset:3200
  buffer_load_dwordx4 v250, s[44:47], s93 offen offset:2048 lds
  v_mfma_f32_16x16x32_bf16 v[32:35], v[120:123], v[152:155], v[32:35]
  ds_read_b64 v[56:57], v11 offset:1152
  v_mfma_f32_16x16x32_bf16 v[24:27], v[112:115], v[152:155], v[24:27]
  ds_read_b64 v[58:59], v11 offset:1160
  v_mfma_f32_16x16x32_bf16 v[28:31], v[116:119], v[152:155], v[28:31]
  ds_read_b128 v[88:91], v12 offset:2688
  v_mfma_f32_16x16x32_bf16 v[28:31], v[124:127], v[144:147], v[28:31]
  ds_read_b64 v[60:61], v11 offset:1664
  v_mfma_f32_16x16x32_bf16 v[32:35], v[124:127], v[148:151], v[32:35]
  ds_read_b64 v[62:63], v11 offset:1672
  v_mfma_f32_16x16x32_bf16 v[36:39], v[124:127], v[152:155], v[36:39]
  ds_read_b128 v[92:95], v12 offset:2176
  buffer_load_dwordx4 v251, s[44:47], s93 offen offset:3072 lds
  v_mfma_f32_16x16x32_bf16 v[40:43], v[124:127], v[156:159], v[40:43]
  ds_read_b64 v[64:65], v11 offset:2176
  v_mfma_f32_16x16x32_bf16 v[28:31], v[112:115], v[156:159], v[28:31]
  ds_read_b64 v[66:67], v11 offset:2184
  v_mfma_f32_16x16x32_bf16 v[32:35], v[116:119], v[156:159], v[32:35]
  ds_read_b128 v[96:99], v12 offset:1664
  v_mfma_f32_16x16x32_bf16 v[36:39], v[120:123], v[156:159], v[36:39]
  ds_read_b64 v[68:69], v11 offset:2688
  v_mfma_f32_16x16x32_bf16 v[32:35], v[128:131], v[144:147], v[32:35]
  ds_read_b64 v[70:71], v11 offset:2696
  v_mfma_f32_16x16x32_bf16 v[36:39], v[128:131], v[148:151], v[36:39]
  ds_read_b128 v[100:103], v12 offset:1152
  s_add_u32 s55, s92, 4096
  s_and_b32 s55, s55, 0x3fff
  s_add_u32 s53, s77, s55
  s_mov_b32 m0, s53
  s_xor_b32 s55, s55, s86
  s_lshl_b32 s55, s55, 3
  s_add_u32 s93, s78, s55
  buffer_load_dwordx4 v184, s[44:47], s93 offen offset:0 lds
  v_mfma_f32_16x16x32_bf16 v[40:43], v[128:131], v[152:155], v[40:43]
  ds_read_b64 v[72:73], v11 offset:3200
  v_mfma_f32_16x16x32_bf16 v[44:47], v[128:131], v[156:159], v[44:47]
  ds_read_b64 v[74:75], v11 offset:3208
  v_mfma_f32_16x16x32_bf16 v[32:35], v[112:115], v[160:163], v[32:35]
  ds_read_b128 v[104:107], v12 offset:640
  v_mfma_f32_16x16x32_bf16 v[36:39], v[116:119], v[160:163], v[36:39]
  ds_read_b64 v[76:77], v11 offset:3712
  v_mfma_f32_16x16x32_bf16 v[40:43], v[120:123], v[160:163], v[40:43]
  ds_read_b64 v[78:79], v11 offset:3720
  v_mfma_f32_16x16x32_bf16 v[44:47], v[124:127], v[160:163], v[44:47]
  ds_read_b128 v[108:111], v12 offset:128
  buffer_load_dwordx4 v249, s[44:47], s93 offen offset:1024 lds
  v_mfma_f32_16x16x32_bf16 v[36:39], v[132:135], v[144:147], v[36:39]
  v_mfma_f32_16x16x32_bf16 v[40:43], v[132:135], v[148:151], v[40:43]
  v_mfma_f32_16x16x32_bf16 v[44:47], v[132:135], v[152:155], v[44:47]
  v_mfma_f32_16x16x32_bf16 v[36:39], v[112:115], v[164:167], v[36:39]
  v_mfma_f32_16x16x32_bf16 v[40:43], v[116:119], v[164:167], v[40:43]
  v_mfma_f32_16x16x32_bf16 v[44:47], v[120:123], v[164:167], v[44:47]
  buffer_load_dwordx4 v250, s[44:47], s93 offen offset:2048 lds
  s_waitcnt vmcnt(7)
  v_min3_u32 v7, v217, v219, v221
  v_mfma_f32_16x16x32_bf16 v[40:43], v[136:139], v[144:147], v[40:43]
  v_max3_u32 v0, v217, v219, v221
  v_min3_u32 v7, v7, v223, v225
  v_mfma_f32_16x16x32_bf16 v[44:47], v[136:139], v[148:151], v[44:47]
  v_max3_u32 v0, v0, v223, v225
  v_min3_u32 v7, v7, v227, v229
  v_mfma_f32_16x16x32_bf16 v[40:43], v[112:115], v[168:171], v[40:43]
  v_max3_u32 v0, v0, v227, v229
  v_min3_u32 v7, v7, v231, v233
  v_mfma_f32_16x16x32_bf16 v[44:47], v[116:119], v[168:171], v[44:47]
  v_max3_u32 v0, v0, v231, v233
  v_min3_u32 v7, v7, v235, v237
  v_mfma_f32_16x16x32_bf16 v[44:47], v[140:143], v[144:147], v[44:47]
  v_max3_u32 v0, v0, v235, v237
  v_min3_u32 v7, v7, v239, v241
  v_mfma_f32_16x16x32_bf16 v[44:47], v[112:115], v[172:175], v[44:47]
  buffer_load_dwordx4 v251, s[44:47], s93 offen offset:3072 lds
  v_max3_u32 v0, v0, v239, v241
  v_min3_u32 v7, v7, v243, v245
  s_waitcnt lgkmcnt(0)
  v_mfma_f32_16x16x32_bf16 v[16:19], v[48:51], v[80:83], v[16:19]
  ds_read_b64 v[112:113], v11 offset:192
  v_max3_u32 v0, v0, v243, v245
  v_mfma_f32_16x16x32_bf16 v[20:23], v[52:55], v[80:83], v[20:23]
  ds_read_b64 v[114:115], v11 offset:200
  v_min_u32 v7, v7, v247
  v_mfma_f32_16x16x32_bf16 v[24:27], v[52:55], v[84:87], v[24:27]
  ds_read_b128 v[144:147], v12 offset:3776
  v_max_u32 v0, v0, v247
  v_mfma_f32_16x16x32_bf16 v[20:23], v[48:51], v[84:87], v[20:23]
  ds_read_b64 v[116:117], v11 offset:704
  s_mov_b32 s82, 0
Lst0:
  v_cmp_ne_u32 vcc, s80, v7
  v_cmp_ne_u32 s[54:55], s80, v0
  s_nop 0
  s_or_b64 vcc, vcc, s[54:55]
  s_cbranch_vccz Lst0ok
  s_mov_b32 s54, 0x1400000
  s_nop 0
  buffer_load_dwordx4 v[216:219], v9, s[32:35], s54 offen offset:0 sc1
  s_mov_b32 s54, 0x1400000
  buffer_load_dwordx4 v[220:223], v9, s[32:35], s54 offen offset:1024 sc1
  s_mov_b32 s54, 0x1400000
  buffer_load_dwordx4 v[224:227], v9, s[32:35], s54 offen offset:2048 sc1
  s_mov_b32 s54, 0x1400000
  buffer_load_dwordx4 v[228:231], v9, s[32:35], s54 offen offset:3072 sc1
  s_mov_b32 s54, 0x1401000
  buffer_load_dwordx4 v[232:235], v9, s[32:35], s54 offen offset:0 sc1
  s_mov_b32 s54, 0x1401000
  buffer_load_dwordx4 v[236:239], v9, s[32:35], s54 offen offset:1024 sc1
  s_mov_b32 s54, 0x1401000
  buffer_load_dwordx4 v[240:243], v9, s[32:35], s54 offen offset:2048 sc1
  s_mov_b32 s54, 0x1401000
  buffer_load_dwordx4 v[244:247], v9, s[32:35], s54 offen offset:3072 sc1
  s_add_u32 s82, s82, 1
  s_cmp_gt_u32 s82, 0x20000
  s_cbranch_scc1 Lend
  s_waitcnt vmcnt(0)
  v_min3_u32 v7, v217, v219, v221
  v_max3_u32 v0, v217, v219, v221
  v_min3_u32 v7, v7, v223, v225
  v_max3_u32 v0, v0, v223, v225
  v_min3_u32 v7, v7, v227, v229
  v_max3_u32 v0, v0, v227, v229
  v_min3_u32 v7, v7, v231, v233
  v_max3_u32 v0, v0, v231, v233
  v_min3_u32 v7, v7, v235, v237
  v_max3_u32 v0, v0, v235, v237
  v_min3_u32 v7, v7, v239, v241
  v_max3_u32 v0, v0, v239, v241
  v_min3_u32 v7, v7, v243, v245
  v_max3_u32 v0, v0, v243, v245
  v_min_u32 v7, v7, v247
  v_max_u32 v0, v0, v247
  s_branch Lst0
Lst0ok:
  v_mfma_f32_16x16x32_bf16 v[24:27], v[56:59], v[80:83], v[24:27]
  ds_read_b64 v[118:119], v11 offset:712
  v_lshlrev_b32 v217, 16, v216
  v_mfma_f32_16x16x32_bf16 v[28:31], v[56:59], v[84:87], v[28:31]
  ds_read_b128 v[148:151], v12 offset:3264
  s_add_u32 s55, s92, 8192
  s_and_b32 s55, s55, 0x3fff
  s_add_u32 s53, s77, s55
  s_mov_b32 m0, s53
  s_xor_b32 s55, s55, s86
  s_lshl_b32 s55, s55, 3
  s_add_u32 s93, s78, s55
  buffer_load_dwordx4 v184, s[44:47], s93 offen offset:0 lds
  v_lshlrev_b32 v219, 16, v218
  v_mfma_f32_16x16x32_bf16 v[32:35], v[56:59], v[88:91], v[32:35]
  ds_read_b64 v[120:121], v11 offset:1216
  v_lshlrev_b32 v221, 16, v220
  v_mfma_f32_16x16x32_bf16 v[24:27], v[48:51], v[88:91], v[24:27]
  ds_read_b64 v[122:123], v11 offset:1224
  v_lshlrev_b32 v223, 16, v222
  v_mfma_f32_16x16x32_bf16 v[28:31], v[52:55], v[88:91], v[28:31]
  ds_read_b128 v[152:155], v12 offset:2752
  v_rcp_f32 v217, v217
  v_mfma_f32_16x16x32_bf16 v[28:31], v[60:63], v[80:83], v[28:31]
  ds_read_b64 v[124:125], v11 offset:1728
  v_and_b32 v216, s61, v216
  v_mfma_f32_16x16x32_bf16 v[32:35], v[60:63], v[84:87], v[32:35]
  ds_read_b64 v[126:127], v11 offset:1736
  v_rcp_f32 v219, v219
  v_mfma_f32_16x16x32_bf16 v[36:39], v[60:63], v[88:91], v[36:39]
  ds_read_b128 v[156:159], v12 offset:2240
  buffer_load_dwordx4 v249, s[44:47], s93 offen offset:1024 lds
  v_and_b32 v218, s61, v218
  v_mfma_f32_16x16x32_bf16 v[40:43], v[60:63], v[92:95], v[40:43]
  ds_read_b64 v[128:129], v11 offset:2240
  v_rcp_f32 v221, v221
  v_mfma_f32_16x16x32_bf16 v[28:31], v[48:51], v[92:95], v[28:31]
  ds_read_b64 v[130:131], v11 offset:2248
  v_and_b32 v220, s61, v220
  v_mfma_f32_16x16x32_bf16 v[32:35], v[52:55], v[92:95], v[32:35]
  ds_read_b128 v[160:163], v12 offset:1728
  v_rcp_f32 v223, v223
  v_mfma_f32_16x16x32_bf16 v[36:39], v[56:59], v[92:95], v[36:39]
  ds_read_b64 v[132:133], v11 offset:2752
  v_and_b32 v222, s61, v222
  v_mfma_f32_16x16x32_bf16 v[32:35], v[64:67], v[80:83], v[32:35]
  ds_read_b64 v[134:135], v11 offset:2760
  v_lshlrev_b32 v225, 16, v224
  v_mfma_f32_16x16x32_bf16 v[36:39], v[64:67], v[84:87], v[36:39]
  ds_read_b128 v[164:167], v12 offset:1216
  buffer_load_dwordx4 v250, s[44:47], s93 offen offset:2048 lds
  v_lshlrev_b32 v227, 16, v226
  v_mfma_f32_16x16x32_bf16 v[40:43], v[64:67], v[88:91], v[40:43]
  ds_read_b64 v[136:137], v11 offset:3264
  v_lshlrev_b32 v229, 16, v228
  v_mfma_f32_16x16x32_bf16 v[44:47], v[64:67], v[92:95], v[44:47]
  ds_read_b64 v[138:139], v11 offset:3272
  v_lshlrev_b32 v231, 16, v230
  v_mfma_f32_16x16x32_bf16 v[32:35], v[48:51], v[96:99], v[32:35]
  ds_read_b128 v[168:171], v12 offset:704
  v_rcp_f32 v225, v225
  v_mfma_f32_16x16x32_bf16 v[36:39], v[52:55], v[96:99], v[36:39]
  ds_read_b64 v[140:141], v11 offset:3776
  v_and_b32 v224, s61, v224
  v_mfma_f32_16x16x32_bf16 v[40:43], v[56:59], v[96:99], v[40:43]
  ds_read_b64 v[142:143], v11 offset:3784
  v_rcp_f32 v227, v227
  v_mfma_f32_16x16x32_bf16 v[44:47], v[60:63], v[96:99], v[44:47]
  ds_read_b128 v[172:175], v12 offset:192
  buffer_load_dwordx4 v251, s[44:47], s93 offen offset:3072 lds
  v_and_b32 v226, s61, v226
  v_mfma_f32_16x16x32_bf16 v[36:39], v[68:71], v[80:83], v[36:39]
  v_rcp_f32 v229, v229
  v_mfma_f32_16x16x32_bf16 v[40:43], v[68:71], v[84:87], v[40:43]
  v_and_b32 v228, s61, v228
  v_rcp_f32 v231, v231
  v_mfma_f32_16x16x32_bf16 v[44:47], v[68:71], v[88:91], v[44:47]
  v_and_b32 v230, s61, v230
  v_lshlrev_b32 v233, 16, v232
  v_mfma_f32_16x16x32_bf16 v[36:39], v[48:51], v[100:103], v[36:39]
  v_lshlrev_b32 v235, 16, v234
  v_lshlrev_b32 v237, 16, v236
  v_mfma_f32_16x16x32_bf16 v[40:43], v[52:55], v[100:103], v[40:43]
  v_lshlrev_b32 v239, 16, v238
  v_rcp_f32 v233, v233
  v_mfma_f32_16x16x32_bf16 v[44:47], v[56:59], v[100:103], v[44:47]
  s_add_u32 s55, s92, 12288
  s_and_b32 s55, s55, 0x3fff
  s_add_u32 s53, s77, s55
  s_mov_b32 m0, s53
  s_xor_b32 s55, s55, s86
  s_lshl_b32 s55, s55, 3
  s_add_u32 s93, s78, s55
  buffer_load_dwordx4 v184, s[44:47], s93 offen offset:0 lds
  v_and_b32 v232, s61, v232
  v_rcp_f32 v235, v235
  v_mfma_f32_16x16x32_bf16 v[40:43], v[72:75], v[80:83], v[40:43]
  v_and_b32 v234, s61, v234
  v_rcp_f32 v237, v237
  v_mfma_f32_16x16x32_bf16 v[44:47], v[72:75], v[84:87], v[44:47]
  v_and_b32 v236, s61, v236
  v_rcp_f32 v239, v239
  v_mfma_f32_16x16x32_bf16 v[40:43], v[48:51], v[104:107], v[40:43]
  v_and_b32 v238, s61, v238
  v_lshlrev_b32 v241, 16, v240
  v_mfma_f32_16x16x32_bf16 v[44:47], v[52:55], v[104:107], v[44:47]
  v_lshlrev_b32 v243, 16, v242
  v_lshlrev_b32 v245, 16, v244
  v_mfma_f32_16x16x32_bf16 v[44:47], v[76:79], v[80:83], v[44:47]
  v_lshlrev_b32 v247, 16, v246
  v_rcp_f32 v241, v241
  v_mfma_f32_16x16x32_bf16 v[44:47], v[48:51], v[108:111], v[44:47]
  buffer_load_dwordx4 v249, s[44:47], s93 offen offset:1024 lds
  v_and_b32 v240, s61, v240
  v_rcp_f32 v243, v243
  s_waitcnt lgkmcnt(0)
  v_mfma_f32_16x16x32_bf16 v[16:19], v[112:115], v[144:147], v[16:19]
  ds_read_b64 v[176:177], v13 offset:1536
  v_and_b32 v242, s61, v242
  v_mfma_f32_16x16x32_bf16 v[20:23], v[116:119], v[144:147], v[20:23]
  ds_read_b64 v[178:179], v13 offset:1024
  v_rcp_f32 v245, v245
  v_mfma_f32_16x16x32_bf16 v[24:27], v[116:119], v[148:151], v[24:27]
  ds_read_b64 v[180:181], v13 offset:512
  v_and_b32 v244, s61, v244
  v_mfma_f32_16x16x32_bf16 v[20:23], v[112:115], v[148:151], v[20:23]
  ds_read_b64 v[182:183], v13 offset:0
  v_rcp_f32 v247, v247
  v_mfma_f32_16x16x32_bf16 v[24:27], v[120:123], v[144:147], v[24:27]
  buffer_store_dwordx4 v[192:195], v14, s[32:35], s88 offen offset:0 sc1
  v_and_b32 v246, s61, v246
  v_lshlrev_b32 v48, 16, v208
  v_mfma_f32_16x16x32_bf16 v[28:31], v[120:123], v[148:151], v[28:31]
  buffer_load_dwordx4 v250, s[44:47], s93 offen offset:2048 lds
  v_and_b32 v49, s61, v208
  v_lshlrev_b32 v50, 16, v209
  v_mfma_f32_16x16x32_bf16 v[32:35], v[120:123], v[152:155], v[32:35]
  v_and_b32 v51, s61, v209
  v_lshlrev_b32 v52, 16, v210
  v_mfma_f32_16x16x32_bf16 v[24:27], v[112:115], v[152:155], v[24:27]
  v_and_b32 v53, s61, v210
  v_lshlrev_b32 v54, 16, v211
  v_mfma_f32_16x16x32_bf16 v[28:31], v[116:119], v[152:155], v[28:31]
  buffer_store_dwordx4 v[196:199], v14, s[32:35], s88 offen offset:1024 sc1
  v_and_b32 v55, s61, v211
  v_lshlrev_b32 v56, 16, v212
  v_mfma_f32_16x16x32_bf16 v[28:31], v[124:127], v[144:147], v[28:31]
  v_and_b32 v57, s61, v212
  v_lshlrev_b32 v58, 16, v213
  v_mfma_f32_16x16x32_bf16 v[32:35], v[124:127], v[148:151], v[32:35]
  v_and_b32 v59, s61, v213
  v_lshlrev_b32 v60, 16, v214
  v_mfma_f32_16x16x32_bf16 v[36:39], v[124:127], v[152:155], v[36:39]
  buffer_load_dwordx4 v251, s[44:47], s93 offen offset:3072 lds
  v_and_b32 v61, s61, v214
  v_lshlrev_b32 v62, 16, v215
  v_mfma_f32_16x16x32_bf16 v[40:43], v[124:127], v[156:159], v[40:43]
  buffer_store_dwordx4 v[200:203], v14, s[32:35], s89 offen offset:0 sc1
  v_and_b32 v63, s61, v215
  v_sub_f32 v64, v48, v216
  v_mfma_f32_16x16x32_bf16 v[28:31], v[112:115], v[156:159], v[28:31]
  v_sub_f32 v65, v49, v218
  v_sub_f32 v66, v50, v220
  v_mfma_f32_16x16x32_bf16 v[32:35], v[116:119], v[156:159], v[32:35]
  v_sub_f32 v67, v51, v222
  v_sub_f32 v68, v52, v224
  v_mfma_f32_16x16x32_bf16 v[36:39], v[120:123], v[156:159], v[36:39]
  v_sub_f32 v69, v53, v226
  v_sub_f32 v70, v54, v228
  v_mfma_f32_16x16x32_bf16 v[32:35], v[128:131], v[144:147], v[32:35]
  buffer_store_dwordx4 v[204:207], v14, s[32:35], s59 offen offset:0 sc1
  v_sub_f32 v71, v55, v230
  v_sub_f32 v72, v56, v232
  v_mfma_f32_16x16x32_bf16 v[36:39], v[128:131], v[148:151], v[36:39]
  v_sub_f32 v73, v57, v234
  v_sub_f32 v74, v58, v236
  v_mfma_f32_16x16x32_bf16 v[40:43], v[128:131], v[152:155], v[40:43]
  v_sub_f32 v75, v59, v238
  v_sub_f32 v76, v60, v240
  v_mfma_f32_16x16x32_bf16 v[44:47], v[128:131], v[156:159], v[44:47]
  v_sub_f32 v77, v61, v242
  v_sub_f32 v78, v62, v244
  v_mfma_f32_16x16x32_bf16 v[32:35], v[112:115], v[160:163], v[32:35]
  s_mov_b64 exec, 0xffff
  buffer_store_dwordx4 v[252:255], v191, s[32:35], s79 offen sc1
  s_mov_b64 exec, -1
  v_sub_f32 v79, v63, v246
  s_waitcnt lgkmcnt(0)
  v_mfma_f32_16x16x32_bf16 v[36:39], v[116:119], v[160:163], v[36:39]
  v_and_b32 v80, s61, v177
  v_lshlrev_b32 v81, 16, v177
  v_mfma_f32_16x16x32_bf16 v[40:43], v[120:123], v[160:163], v[40:43]
  v_and_b32 v82, s61, v176
  v_lshlrev_b32 v83, 16, v176
  v_mfma_f32_16x16x32_bf16 v[44:47], v[124:127], v[160:163], v[44:47]
  v_and_b32 v84, s61, v179
  v_lshlrev_b32 v85, 16, v179
  v_mfma_f32_16x16x32_bf16 v[36:39], v[132:135], v[144:147], v[36:39]
  v_and_b32 v86, s61, v178
  v_lshlrev_b32 v87, 16, v178
  v_mfma_f32_16x16x32_bf16 v[40:43], v[132:135], v[148:151], v[40:43]
  v_and_b32 v88, s61, v181
  v_lshlrev_b32 v89, 16, v181
  v_mfma_f32_16x16x32_bf16 v[44:47], v[132:135], v[152:155], v[44:47]
  v_and_b32 v90, s61, v180
  v_lshlrev_b32 v91, 16, v180
  v_mfma_f32_16x16x32_bf16 v[36:39], v[112:115], v[164:167], v[36:39]
  v_and_b32 v92, s61, v183
  v_lshlrev_b32 v93, 16, v183
  v_mfma_f32_16x16x32_bf16 v[40:43], v[116:119], v[164:167], v[40:43]
  v_and_b32 v94, s61, v182
  v_lshlrev_b32 v95, 16, v182
  v_mfma_f32_16x16x32_bf16 v[44:47], v[120:123], v[164:167], v[44:47]
  v_mul_f32 v64, v64, v217
  v_mul_f32 v65, v65, v219
  v_mfma_f32_16x16x32_bf16 v[40:43], v[136:139], v[144:147], v[40:43]
  v_mul_f32 v66, v66, v221
  v_mul_f32 v67, v67, v223
  v_mfma_f32_16x16x32_bf16 v[44:47], v[136:139], v[148:151], v[44:47]
  v_mul_f32 v68, v68, v225
  v_mul_f32 v69, v69, v227
  v_mfma_f32_16x16x32_bf16 v[40:43], v[112:115], v[168:171], v[40:43]
  v_mul_f32 v70, v70, v229
  v_mul_f32 v71, v71, v231
  v_mfma_f32_16x16x32_bf16 v[44:47], v[116:119], v[168:171], v[44:47]
  v_mul_f32 v72, v72, v233
  v_mul_f32 v73, v73, v235
  v_mfma_f32_16x16x32_bf16 v[44:47], v[140:143], v[144:147], v[44:47]
  v_mul_f32 v74, v74, v237
  v_mul_f32 v75, v75, v239
  v_mfma_f32_16x16x32_bf16 v[44:47], v[112:115], v[172:175], v[44:47]
  v_mul_f32 v76, v76, v241
  v_mul_f32 v77, v77, v243
  s_cmp_eq_u32 s51, 0
  s_cbranch_scc1 Lck0
  ds_write_b128 v189, v[16:19] offset:0
  ds_write_b128 v189, v[20:23] offset:1024
  ds_write_b128 v189, v[24:27] offset:2048
  ds_write_b128 v189, v[28:31] offset:3072
  v_pk_fma_f32 v[80:81], v[80:81], s[64:65], v[32:33] op_sel:[0,1,0] op_sel_hi:[1,1,1]
  v_pk_fma_f32 v[82:83], v[82:83], s[64:65], v[34:35] op_sel:[0,1,0] op_sel_hi:[1,1,1]
  v_pk_fma_f32 v[84:85], v[84:85], s[64:65], v[36:37] op_sel:[0,1,0] op_sel_hi:[1,1,1]
  v_pk_fma_f32 v[86:87], v[86:87], s[64:65], v[38:39] op_sel:[0,1,0] op_sel_hi:[1,1,1]
  v_pk_fma_f32 v[88:89], v[88:89], s[64:65], v[40:41] op_sel:[0,1,0] op_sel_hi:[1,1,1]
  v_pk_fma_f32 v[90:91], v[90:91], s[64:65], v[42:43] op_sel:[0,1,0] op_sel_hi:[1,1,1]
  v_pk_fma_f32 v[92:93], v[92:93], s[64:65], v[44:45] op_sel:[0,1,0] op_sel_hi:[1,1,1]
  v_pk_fma_f32 v[94:95], v[94:95], s[64:65], v[46:47] op_sel:[0,1,0] op_sel_hi:[1,1,1]
  s_branch Lck1
Lck0:
  ds_write_b128 v189, v[32:35] offset:0
  ds_write_b128 v189, v[36:39] offset:1024
  ds_write_b128 v189, v[40:43] offset:2048
  s_nop 0
  ds_write_b128 v189, v[44:47] offset:3072
  v_pk_fma_f32 v[80:81], v[80:81], s[64:65], v[16:17] op_sel:[0,1,0] op_sel_hi:[1,1,1]
  v_pk_fma_f32 v[82:83], v[82:83], s[64:65], v[18:19] op_sel:[0,1,0] op_sel_hi:[1,1,1]
  v_pk_fma_f32 v[84:85], v[84:85], s[64:65], v[20:21] op_sel:[0,1,0] op_sel_hi:[1,1,1]
  v_pk_fma_f32 v[86:87], v[86:87], s[64:65], v[22:23] op_sel:[0,1,0] op_sel_hi:[1,1,1]
  v_pk_fma_f32 v[88:89], v[88:89], s[64:65], v[24:25] op_sel:[0,1,0] op_sel_hi:[1,1,1]
  v_pk_fma_f32 v[90:91], v[90:91], s[64:65], v[26:27] op_sel:[0,1,0] op_sel_hi:[1,1,1]
  v_pk_fma_f32 v[92:93], v[92:93], s[64:65], v[28:29] op_sel:[0,1,0] op_sel_hi:[1,1,1]
  v_pk_fma_f32 v[94:95], v[94:95], s[64:65], v[30:31] op_sel:[0,1,0] op_sel_hi:[1,1,1]
Lck1:
  v_mul_f32 v78, v78, v245
  v_mul_f32 v79, v79, v247
  s_waitcnt lgkmcnt(0)
  s_barrier
  ds_read_b128 v[112:115], v190 offset:0
  ds_read_b128 v[116:119], v190 offset:1024
  ds_read_b128 v[120:123], v190 offset:2048
  ds_read_b128 v[124:127], v190 offset:3072
  s_waitcnt lgkmcnt(3)
  v_pk_add_f32 v[80:81], v[80:81], v[112:113]
  v_pk_add_f32 v[82:83], v[82:83], v[114:115]
  v_pk_fma_f32 v[48:49], v[64:65], v[80:81], v[48:49]
  v_pk_fma_f32 v[50:51], v[66:67], v[82:83], v[50:51]
  v_cvt_pk_bf16_f32 v128, v48, v49
  v_cvt_pk_bf16_f32 v129, v50, v51
  s_waitcnt lgkmcnt(2)
  v_pk_add_f32 v[84:85], v[84:85], v[116:117]
  v_pk_add_f32 v[86:87], v[86:87], v[118:119]
  v_pk_fma_f32 v[52:53], v[68:69], v[84:85], v[52:53]
  v_pk_fma_f32 v[54:55], v[70:71], v[86:87], v[54:55]
  v_cvt_pk_bf16_f32 v130, v52, v53
  v_cvt_pk_bf16_f32 v131, v54, v55
  s_nop 0
  v_permlane16_swap_b32 v128, v130
  v_permlane16_swap_b32 v129, v131
  buffer_store_dwordx4 v[128:131], v185, s[32:35], s57 offen sc1
  s_waitcnt lgkmcnt(1)
  v_pk_add_f32 v[88:89], v[88:89], v[120:121]
  v_pk_add_f32 v[90:91], v[90:91], v[122:123]
  v_pk_fma_f32 v[56:57], v[72:73], v[88:89], v[56:57]
  v_pk_fma_f32 v[58:59], v[74:75], v[90:91], v[58:59]
  v_cvt_pk_bf16_f32 v132, v56, v57
  v_cvt_pk_bf16_f32 v133, v58, v59
  s_waitcnt lgkmcnt(0)
  v_pk_add_f32 v[92:93], v[92:93], v[124:125]
  v_pk_add_f32 v[94:95], v[94:95], v[126:127]
  v_pk_fma_f32 v[60:61], v[76:77], v[92:93], v[60:61]
  v_pk_fma_f32 v[62:63], v[78:79], v[94:95], v[62:63]
  v_cvt_pk_bf16_f32 v134, v60, v61
  v_cvt_pk_bf16_f32 v135, v62, v63
  s_nop 0
  v_permlane16_swap_b32 v132, v134
  v_permlane16_swap_b32 v133, v135
  buffer_store_dwordx4 v[132:135], v185, s[32:35], s58 offen sc1
  s_lshl_b32 s53, s52, 6
  s_add_u32 s54, s53, s77
  v_xor_b32 v9, s54, v188
  v_xor_b32 v8, 64, v9
  s_waitcnt vmcnt(5)
  ds_read_b64_tr_b16 a[0:1], v8 offset:0
  ds_read_b64_tr_b16 a[2:3], v8 offset:512
  ds_read_b64_tr_b16 a[4:5], v9 offset:0
  ds_read_b64_tr_b16 a[6:7], v9 offset:512
  ds_read_b64_tr_b16 a[8:9], v8 offset:2048
  ds_read_b64_tr_b16 a[10:11], v8 offset:2560
  ds_read_b64_tr_b16 a[12:13], v9 offset:2048
  ds_read_b64_tr_b16 a[14:15], v9 offset:2560
  ds_read_b64_tr_b16 a[16:17], v8 offset:4096
  ds_read_b64_tr_b16 a[18:19], v8 offset:4608
  ds_read_b64_tr_b16 a[20:21], v9 offset:4096
  ds_read_b64_tr_b16 a[22:23], v9 offset:4608
  ds_read_b64_tr_b16 a[24:25], v8 offset:6144
  ds_read_b64_tr_b16 a[26:27], v8 offset:6656
  ds_read_b64_tr_b16 a[28:29], v9 offset:6144
  ds_read_b64_tr_b16 a[30:31], v9 offset:6656
  ds_read_b64_tr_b16 a[32:33], v8 offset:8192
  ds_read_b64_tr_b16 a[34:35], v8 offset:8704
  ds_read_b64_tr_b16 a[36:37], v9 offset:8192
  ds_read_b64_tr_b16 a[38:39], v9 offset:8704
  ds_read_b64_tr_b16 a[40:41], v8 offset:10240
  ds_read_b64_tr_b16 a[42:43], v8 offset:10752
  ds_read_b64_tr_b16 a[44:45], v9 offset:10240
  ds_read_b64_tr_b16 a[46:47], v9 offset:10752
  ds_read_b64_tr_b16 a[48:49], v8 offset:12288
  ds_read_b64_tr_b16 a[50:51], v8 offset:12800
  ds_read_b64_tr_b16 a[52:53], v9 offset:12288
  ds_read_b64_tr_b16 a[54:55], v9 offset:12800
  ds_read_b64_tr_b16 a[56:57], v8 offset:14336
  ds_read_b64_tr_b16 a[58:59], v8 offset:14848
  ds_read_b64_tr_b16 a[60:61], v9 offset:14336
  ds_read_b64_tr_b16 a[62:63], v9 offset:14848
  s_lshl_b32 s53, s50, 5
  s_add_u32 s53, s53, s49
  s_mul_i32 s53, s53, 8
  s_add_u32 s58, s53, 0x1470000
  v_mul_u32_u24 v7, 2048, v1
  s_xor_b32 s53, s48, 3
  s_mul_i32 s53, s53, 12288
  s_add_u32 s53, s53, 65536
  v_add_u32 v10, s53, v14
  s_xor_b32 s53, s48, 1
  s_mul_i32 s53, s53, 12288
  s_add_u32 s53, s53, 69632
  v_add_u32 v11, s53, v14
  s_xor_b32 s53, s48, 2
  s_mul_i32 s53, s53, 12288
  s_add_u32 s53, s53, 73728
  v_add_u32 v12, s53, v14
  s_mul_i32 s53, s48, 12288
  s_add_u32 s53, s53, 65536
  v_add_u32 v13, s53, v14
  v_mov_b32 v160, 0x3f803f80
  v_mov_b32 v161, 0x3f803f80
  v_mov_b32 v162, 0x3f803f80
  v_mov_b32 v163, 0x3f803f80
  s_waitcnt lgkmcnt(0)
  s_waitcnt vmcnt(0)
  s_barrier
  s_cmp_lg_u32 s48, 0
  s_cbranch_scc1 Lsig2
  s_mov_b64 exec, 255
  buffer_store_dwordx2 v[2:3], v7, s[32:35], s58 offen sc1
  s_mov_b64 exec, -1
Lsig2:
  s_add_u32 s55, s92, 0
  s_and_b32 s55, s55, 0x3fff
  s_add_u32 s53, s77, s55
  s_mov_b32 m0, s53
  s_lshl_b32 s55, s55, 3
  s_add_u32 s93, s78, s55
  buffer_load_dwordx4 v184, s[40:43], s93 offen offset:0 lds
  buffer_load_dwordx4 v249, s[40:43], s93 offen offset:1024 lds
  buffer_load_dwordx4 v250, s[40:43], s93 offen offset:2048 lds
  buffer_load_dwordx4 v251, s[40:43], s93 offen offset:3072 lds
  v_and_b32 v164, 31, v1
  v_lshlrev_b32 v164, 2, v164
  s_lshl_b32 s53, s52, 7
  s_add_u32 s53, s53, 131072
  v_add_u32 v165, s53, v164
  s_lshl_b32 s53, s48, 8
  v_add_u32 v166, s53, v165
  v_xor_b32 v167, 0x80, v166
  s_lshl_b32 s53, s48, 7
  s_add_u32 s53, s53, 132096
  v_add_u32 v168, s53, v164
  v_lshrrev_b32 v169, 5, v1
  v_lshl_add_u32 v169, v169, 4, s53
  v_mfma_f32_32x32x16_bf16 v[16:31], v[160:163], a[0:3], 0
  v_mfma_f32_32x32x16_bf16 v[32:47], v[160:163], a[4:7], 0
  s_add_u32 s55, s92, 4096
  s_and_b32 s55, s55, 0x3fff
  s_add_u32 s53, s77, s55
  s_mov_b32 m0, s53
  s_lshl_b32 s55, s55, 3
  s_add_u32 s93, s78, s55
  buffer_load_dwordx4 v184, s[40:43], s93 offen offset:0 lds
  v_mfma_f32_32x32x16_bf16 v[16:31], v[160:163], a[8:11], v[16:31]
  v_mfma_f32_32x32x16_bf16 v[32:47], v[160:163], a[12:15], v[32:47]
  buffer_load_dwordx4 v249, s[40:43], s93 offen offset:1024 lds
  v_mfma_f32_32x32x16_bf16 v[16:31], v[160:163], a[16:19], v[16:31]
  v_mfma_f32_32x32x16_bf16 v[32:47], v[160:163], a[20:23], v[32:47]
  buffer_load_dwordx4 v250, s[40:43], s93 offen offset:2048 lds
  v_mfma_f32_32x32x16_bf16 v[16:31], v[160:163], a[24:27], v[16:31]
  v_mfma_f32_32x32x16_bf16 v[32:47], v[160:163], a[28:31], v[32:47]
  buffer_load_dwordx4 v251, s[40:43], s93 offen offset:3072 lds
  v_mfma_f32_32x32x16_bf16 v[16:31], v[160:163], a[32:35], v[16:31]
  v_mfma_f32_32x32x16_bf16 v[32:47], v[160:163], a[36:39], v[32:47]
  s_add_u32 s55, s92, 8192
  s_and_b32 s55, s55, 0x3fff
  s_add_u32 s53, s77, s55
  s_mov_b32 m0, s53
  s_lshl_b32 s55, s55, 3
  s_add_u32 s93, s78, s55
  buffer_load_dwordx4 v184, s[40:43], s93 offen offset:0 lds
  v_mfma_f32_32x32x16_bf16 v[16:31], v[160:163], a[40:43], v[16:31]
  v_mfma_f32_32x32x16_bf16 v[32:47], v[160:163], a[44:47], v[32:47]
  buffer_load_dwordx4 v249, s[40:43], s93 offen offset:1024 lds
  v_mfma_f32_32x32x16_bf16 v[16:31], v[160:163], a[48:51], v[16:31]
  v_mfma_f32_32x32x16_bf16 v[32:47], v[160:163], a[52:55], v[32:47]
  buffer_load_dwordx4 v250, s[40:43], s93 offen offset:2048 lds
  v_mfma_f32_32x32x16_bf16 v[16:31], v[160:163], a[56:59], v[16:31]
  v_mfma_f32_32x32x16_bf16 v[32:47], v[160:163], a[60:63], v[32:47]
  buffer_load_dwordx4 v251, s[40:43], s93 offen offset:3072 lds
  s_add_u32 s55, s92, 12288
  s_and_b32 s55, s55, 0x3fff
  s_add_u32 s53, s77, s55
  s_mov_b32 m0, s53
  s_lshl_b32 s55, s55, 3
  s_add_u32 s93, s78, s55
  buffer_load_dwordx4 v184, s[40:43], s93 offen offset:0 lds
  buffer_load_dwordx4 v249, s[40:43], s93 offen offset:1024 lds
  buffer_load_dwordx4 v250, s[40:43], s93 offen offset:2048 lds
  buffer_load_dwordx4 v251, s[40:43], s93 offen offset:3072 lds
  s_add_u32 s36, s30, 0x1160000
  s_addc_u32 s37, s31, 0
  s_mov_b32 s38, 0x158000
  s_mov_b32 s39, 0x20000
  s_add_u32 s40, s30, 0x1000000
  s_addc_u32 s41, s31, 0
  s_mov_b32 s42, 0x158000
  s_mov_b32 s43, 0x20000
  ds_write_b32 v167, v16
  ds_write_b32 v166, v32
  v_lshlrev_b32 v189, 6, v6
  v_and_b32 v189, 64, v189
  v_xor_b32 v189, v189, v14
  s_lshl_b32 s56, s48, 14
  s_lshl_b32 s53, s51, 6
  s_add_u32 s54, s53, s56
  v_xor_b32 v191, s54, v187
  v_xor_b32 v190, 64, v191
  s_lshl_b32 s54, s69, 13
  s_add_u32 s53, s53, s54
  s_lshl_b32 s54, s52, 12
  s_add_u32 s53, s53, s54
  v_xor_b32 v187, s53, v187
  s_and_b32 s57, s50, 7
  s_lshl_b32 s57, s57, 2
  s_add_u32 s53, s57, s48
  s_mul_i32 s53, s53, 512
  s_add_u32 s58, s53, 0x1470000
  v_lshlrev_b32 v4, 3, v1
  v_mul_u32_u24 v0, 8, v1
  s_lshl_b32 s57, s68, 16
  s_add_u32 s57, s57, s56
  s_add_u32 s57, s57, 0x400000
  s_or_b32 s57, s57, s86
  v_xor_b32 v187, s86, v187
  s_waitcnt lgkmcnt(0)
  s_barrier
  ds_read_b32 v80, v165 offset:0
  ds_read_b32 v81, v165 offset:256
  ds_read_b32 v82, v165 offset:512
  ds_read_b32 v83, v165 offset:768
  s_xor_b32 s53, s51, 1
  s_lshl_b32 s53, s53, 8
  v_xor_b32 v184, s53, v4
  s_lshl_b32 s53, s48, 9
  s_add_u32 s53, s53, 114688
  v_add_u32 v184, s53, v184
  v_and_b32 v7, 31, v1
  s_lshl_b32 s53, s51, 5
  v_add_u32 v7, s53, v7
  v_lshlrev_b32 v185, 3, v7
  v_add_u32 v185, 114688, v185
  s_waitcnt lgkmcnt(0)
  v_add_f32 v80, v80, v81
  v_add_f32 v82, v82, v83
  v_add_f32 v80, v80, v82
  ds_write_b32 v168, v80
  ds_read_b128 v[144:147], v169 offset:0
  ds_read_b128 v[148:151], v169 offset:32
  ds_read_b128 v[152:155], v169 offset:64
  ds_read_b128 v[156:159], v169 offset:96
  s_lshl_b32 s53, s69, 12
  s_lshl_b32 s54, s52, 11
  s_add_u32 s70, s53, s54
  s_mul_i32 s73, s69, 11
  s_mul_i32 s53, s48, 3
  s_add_u32 s73, s73, s53
  s_lshl_b32 s74, s73, 14
  s_add_u32 s75, s74, 0x8000
  s_cmp_eq_u32 s48, 3
  s_cselect_b32 s75, 0x400000, s75
  s_or_b32 s74, s74, s92
  s_or_b32 s75, s75, s92
  s_add_u32 s88, s74, 0x4000
  s_lshl_b32 s72, s68, 8
  s_lshl_b32 s53, s69, 3
  s_add_u32 s79, s72, s53
  s_lshl_b32 s53, s48, 4
  s_add_u32 s72, s72, s53
  s_lshl_b32 s66, s68, 1
  s_add_u32 s66, s66, s51
  s_lshl_b32 s71, s66, 15
  s_add_u32 s71, s71, s70
  s_add_u32 s71, s71, 0x600000
  v_mov_b32 v172, 0
  v_mov_b32 v173, 0
  v_mov_b32 v174, 0
  v_mov_b32 v175, 0
  s_mov_b32 m0, s56
  s_waitcnt vmcnt(0)
  s_mov_b32 s82, 0
  buffer_load_dwordx2 v[16:17], v0, s[32:35], s58 offen sc1
  ds_read_b64_tr_b16 a[64:65], v8 offset:0
  ds_read_b64_tr_b16 a[66:67], v8 offset:512
  ds_read_b64_tr_b16 a[68:69], v9 offset:0
  ds_read_b64_tr_b16 a[70:71], v9 offset:512
  ds_read_b64_tr_b16 a[72:73], v8 offset:2048
  ds_read_b64_tr_b16 a[74:75], v8 offset:2560
  ds_read_b64_tr_b16 a[76:77], v9 offset:2048
  ds_read_b64_tr_b16 a[78:79], v9 offset:2560
  ds_read_b64_tr_b16 a[80:81], v8 offset:4096
  ds_read_b64_tr_b16 a[82:83], v8 offset:4608
  ds_read_b64_tr_b16 a[84:85], v9 offset:4096
  ds_read_b64_tr_b16 a[86:87], v9 offset:4608
  ds_read_b64_tr_b16 a[88:89], v8 offset:6144
  ds_read_b64_tr_b16 a[90:91], v8 offset:6656
  ds_read_b64_tr_b16 a[92:93], v9 offset:6144
  ds_read_b64_tr_b16 a[94:95], v9 offset:6656
  ds_read_b64_tr_b16 a[96:97], v8 offset:8192
  ds_read_b64_tr_b16 a[98:99], v8 offset:8704
  ds_read_b64_tr_b16 a[100:101], v9 offset:8192
  ds_read_b64_tr_b16 a[102:103], v9 offset:8704
  ds_read_b64_tr_b16 a[104:105], v8 offset:10240
  ds_read_b64_tr_b16 a[106:107], v8 offset:10752
  ds_read_b64_tr_b16 a[108:109], v9 offset:10240
  ds_read_b64_tr_b16 a[110:111], v9 offset:10752
  ds_read_b64_tr_b16 a[112:113], v8 offset:12288
  ds_read_b64_tr_b16 a[114:115], v8 offset:12800
  ds_read_b64_tr_b16 a[116:117], v9 offset:12288
  ds_read_b64_tr_b16 a[118:119], v9 offset:12800
  ds_read_b64_tr_b16 a[120:121], v8 offset:14336
  ds_read_b64_tr_b16 a[122:123], v8 offset:14848
  ds_read_b64_tr_b16 a[124:125], v9 offset:14336
  ds_read_b64_tr_b16 a[126:127], v9 offset:14848
Lpoll3:
  s_waitcnt vmcnt(0)
  v_cmp_ne_u64 vcc, s[80:81], v[16:17]
  s_cbranch_vccz Lpolld3
  buffer_load_dwordx2 v[16:17], v0, s[32:35], s58 offen sc1
  s_add_u32 s82, s82, 1
  s_cmp_gt_u32 s82, 0x20000
  s_cbranch_scc1 Lend
  s_branch Lpoll3
Lpolld3:
  s_xor_b32 s93, s57, 0
  buffer_load_dwordx4 v189, s[32:35], s93 offen offset:0 sc1 lds
  buffer_load_dwordx4 v189, s[32:35], s93 offen offset:1024 sc1 lds
  buffer_load_dwordx4 v189, s[32:35], s93 offen offset:2048 sc1 lds
  buffer_load_dwordx4 v189, s[32:35], s93 offen offset:3072 sc1 lds
  s_add_u32 s53, s56, 4096
  s_mov_b32 m0, s53
  s_xor_b32 s93, s57, 4096
  buffer_load_dwordx4 v189, s[32:35], s93 offen offset:0 sc1 lds
  buffer_load_dwordx4 v189, s[32:35], s93 offen offset:1024 sc1 lds
  buffer_load_dwordx4 v189, s[32:35], s93 offen offset:2048 sc1 lds
  buffer_load_dwordx4 v189, s[32:35], s93 offen offset:3072 sc1 lds
  s_waitcnt vmcnt(6)
  ds_read_b64_tr_b16 v[80:81], v190 offset:0
  ds_read_b64_tr_b16 v[82:83], v190 offset:512
  ds_read_b64_tr_b16 v[112:113], v191 offset:0
  ds_read_b64_tr_b16 v[114:115], v191 offset:512
  s_waitcnt vmcnt(4)
  ds_read_b64_tr_b16 v[84:85], v190 offset:2048
  ds_read_b64_tr_b16 v[86:87], v190 offset:2560
  ds_read_b64_tr_b16 v[116:117], v191 offset:2048
  ds_read_b64_tr_b16 v[118:119], v191 offset:2560
  s_waitcnt lgkmcnt(4)
  v_mfma_f32_32x32x16_bf16 v[16:31], a[0:3], v[80:83], 0
  s_add_u32 s53, s56, 8192
  s_mov_b32 m0, s53
  s_xor_b32 s93, s57, 8192
  buffer_load_dwordx4 v189, s[32:35], s93 offen offset:0 sc1 lds
  v_mfma_f32_32x32x16_bf16 v[32:47], a[4:7], v[80:83], 0
  v_mfma_f32_32x32x16_bf16 v[48:63], a[0:3], v[112:115], 0
  buffer_load_dwordx4 v189, s[32:35], s93 offen offset:1024 sc1 lds
  v_mfma_f32_32x32x16_bf16 v[64:79], a[4:7], v[112:115], 0
  s_waitcnt vmcnt(4)
  ds_read_b64_tr_b16 v[88:89], v190 offset:4096
  ds_read_b64_tr_b16 v[90:91], v190 offset:4608
  ds_read_b64_tr_b16 v[120:121], v191 offset:4096
  ds_read_b64_tr_b16 v[122:123], v191 offset:4608
  s_waitcnt lgkmcnt(4)
  v_mfma_f32_32x32x16_bf16 v[16:31], a[8:11], v[84:87], v[16:31]
  buffer_load_dwordx4 v189, s[32:35], s93 offen offset:2048 sc1 lds
  v_mfma_f32_32x32x16_bf16 v[32:47], a[12:15], v[84:87], v[32:47]
  v_mfma_f32_32x32x16_bf16 v[48:63], a[8:11], v[116:119], v[48:63]
  buffer_load_dwordx4 v189, s[32:35], s93 offen offset:3072 sc1 lds
  v_mfma_f32_32x32x16_bf16 v[64:79], a[12:15], v[116:119], v[64:79]
  s_waitcnt vmcnt(4)
  ds_read_b64_tr_b16 v[92:93], v190 offset:6144
  ds_read_b64_tr_b16 v[94:95], v190 offset:6656
  ds_read_b64_tr_b16 v[124:125], v191 offset:6144
  ds_read_b64_tr_b16 v[126:127], v191 offset:6656
  s_waitcnt lgkmcnt(4)
  v_mfma_f32_32x32x16_bf16 v[16:31], a[16:19], v[88:91], v[16:31]
  s_add_u32 s53, s56, 12288
  s_mov_b32 m0, s53
  s_xor_b32 s93, s57, 12288
  buffer_load_dwordx4 v189, s[32:35], s93 offen offset:0 sc1 lds
  v_mfma_f32_32x32x16_bf16 v[32:47], a[20:23], v[88:91], v[32:47]
  v_mfma_f32_32x32x16_bf16 v[48:63], a[16:19], v[120:123], v[48:63]
  buffer_load_dwordx4 v189, s[32:35], s93 offen offset:1024 sc1 lds
  v_mfma_f32_32x32x16_bf16 v[64:79], a[20:23], v[120:123], v[64:79]
  s_waitcnt vmcnt(4)
  ds_read_b64_tr_b16 v[96:97], v190 offset:8192
  ds_read_b64_tr_b16 v[98:99], v190 offset:8704
  ds_read_b64_tr_b16 v[128:129], v191 offset:8192
  ds_read_b64_tr_b16 v[130:131], v191 offset:8704
  s_waitcnt lgkmcnt(4)
  v_mfma_f32_32x32x16_bf16 v[16:31], a[24:27], v[92:95], v[16:31]
  buffer_load_dwordx4 v189, s[32:35], s93 offen offset:2048 sc1 lds
  v_mfma_f32_32x32x16_bf16 v[32:47], a[28:31], v[92:95], v[32:47]
  v_mfma_f32_32x32x16_bf16 v[48:63], a[24:27], v[124:127], v[48:63]
  buffer_load_dwordx4 v189, s[32:35], s93 offen offset:3072 sc1 lds
  v_mfma_f32_32x32x16_bf16 v[64:79], a[28:31], v[124:127], v[64:79]
  s_waitcnt vmcnt(4)
  ds_read_b64_tr_b16 v[100:101], v190 offset:10240
  ds_read_b64_tr_b16 v[102:103], v190 offset:10752
  ds_read_b64_tr_b16 v[132:133], v191 offset:10240
  ds_read_b64_tr_b16 v[134:135], v191 offset:10752
  s_waitcnt lgkmcnt(4)
  s_barrier
  v_mfma_f32_32x32x16_bf16 v[16:31], a[32:35], v[96:99], v[16:31]
  v_mfma_f32_32x32x16_bf16 v[32:47], a[36:39], v[96:99], v[32:47]
  v_mfma_f32_32x32x16_bf16 v[48:63], a[32:35], v[128:131], v[48:63]
  v_mfma_f32_32x32x16_bf16 v[64:79], a[36:39], v[128:131], v[64:79]
  s_waitcnt vmcnt(2)
  ds_read_b64_tr_b16 v[104:105], v190 offset:12288
  ds_read_b64_tr_b16 v[106:107], v190 offset:12800
  ds_read_b64_tr_b16 v[136:137], v191 offset:12288
  ds_read_b64_tr_b16 v[138:139], v191 offset:12800
  s_waitcnt lgkmcnt(4)
  v_mfma_f32_32x32x16_bf16 v[16:31], a[40:43], v[100:103], v[16:31]
  v_mfma_f32_32x32x16_bf16 v[32:47], a[44:47], v[100:103], v[32:47]
  v_mfma_f32_32x32x16_bf16 v[48:63], a[40:43], v[132:135], v[48:63]
  v_mfma_f32_32x32x16_bf16 v[64:79], a[44:47], v[132:135], v[64:79]
  s_waitcnt vmcnt(0)
  ds_read_b64_tr_b16 v[108:109], v190 offset:14336
  ds_read_b64_tr_b16 v[110:111], v190 offset:14848
  ds_read_b64_tr_b16 v[140:141], v191 offset:14336
  ds_read_b64_tr_b16 v[142:143], v191 offset:14848
  s_waitcnt lgkmcnt(4)
  v_mfma_f32_32x32x16_bf16 v[16:31], a[48:51], v[104:107], v[16:31]
  s_xor_b32 s87, s88, 0
  buffer_load_dwordx4 a[128:131], v14, s[40:43], s87 offen
  v_mfma_f32_32x32x16_bf16 v[32:47], a[52:55], v[104:107], v[32:47]
  v_mfma_f32_32x32x16_bf16 v[48:63], a[48:51], v[136:139], v[48:63]
  s_xor_b32 s87, s88, 1024
  buffer_load_dwordx4 a[132:135], v14, s[40:43], s87 offen
  v_mfma_f32_32x32x16_bf16 v[64:79], a[52:55], v[136:139], v[64:79]
  s_waitcnt lgkmcnt(0)
  v_mfma_f32_32x32x16_bf16 v[16:31], a[56:59], v[108:111], v[16:31]
  s_xor_b32 s87, s88, 2048
  buffer_load_dwordx4 a[136:139], v14, s[40:43], s87 offen
  v_mfma_f32_32x32x16_bf16 v[32:47], a[60:63], v[108:111], v[32:47]
  v_mfma_f32_32x32x16_bf16 v[48:63], a[56:59], v[140:143], v[48:63]
  s_xor_b32 s87, s88, 3072
  buffer_load_dwordx4 a[140:143], v14, s[40:43], s87 offen
  v_mfma_f32_32x32x16_bf16 v[64:79], a[60:63], v[140:143], v[64:79]
  v_dot2c_f32_bf16 v172, v80, v160
  v_dot2c_f32_bf16 v174, v80, v80
  v_dot2c_f32_bf16 v172, v81, v160
  v_dot2c_f32_bf16 v174, v81, v81
  v_dot2c_f32_bf16 v172, v82, v160
  v_dot2c_f32_bf16 v174, v82, v82
  v_dot2c_f32_bf16 v172, v83, v160
  v_dot2c_f32_bf16 v174, v83, v83
  v_dot2c_f32_bf16 v173, v112, v160
  v_dot2c_f32_bf16 v175, v112, v112
  v_dot2c_f32_bf16 v173, v113, v160
  v_dot2c_f32_bf16 v175, v113, v113
  ds_write_b128 v10, v[16:19] offset:0
  s_xor_b32 s87, s88, 4096
  buffer_load_dwordx4 a[144:147], v14, s[40:43], s87 offen
  v_dot2c_f32_bf16 v173, v114, v160
  v_dot2c_f32_bf16 v175, v114, v114
  v_dot2c_f32_bf16 v173, v115, v160
  v_dot2c_f32_bf16 v175, v115, v115
  v_dot2c_f32_bf16 v172, v84, v160
  v_dot2c_f32_bf16 v174, v84, v84
  v_dot2c_f32_bf16 v172, v85, v160
  v_dot2c_f32_bf16 v174, v85, v85
  ds_write_b128 v10, v[20:23] offset:1024
  v_dot2c_f32_bf16 v172, v86, v160
  v_dot2c_f32_bf16 v174, v86, v86
  v_dot2c_f32_bf16 v172, v87, v160
  v_dot2c_f32_bf16 v174, v87, v87
  s_xor_b32 s87, s88, 5120
  buffer_load_dwordx4 a[148:151], v14, s[40:43], s87 offen
  v_dot2c_f32_bf16 v173, v116, v160
  v_dot2c_f32_bf16 v175, v116, v116
  v_dot2c_f32_bf16 v173, v117, v160
  v_dot2c_f32_bf16 v175, v117, v117
  ds_write_b128 v10, v[24:27] offset:2048
  v_dot2c_f32_bf16 v173, v118, v160
  v_dot2c_f32_bf16 v175, v118, v118
  v_dot2c_f32_bf16 v173, v119, v160
  v_dot2c_f32_bf16 v175, v119, v119
  v_dot2c_f32_bf16 v172, v88, v160
  v_dot2c_f32_bf16 v174, v88, v88
  v_dot2c_f32_bf16 v172, v89, v160
  v_dot2c_f32_bf16 v174, v89, v89
  ds_write_b128 v10, v[28:31] offset:3072
  s_xor_b32 s87, s88, 6144
  buffer_load_dwordx4 a[152:155], v14, s[40:43], s87 offen
  v_dot2c_f32_bf16 v172, v90, v160
  v_dot2c_f32_bf16 v174, v90, v90
  v_dot2c_f32_bf16 v172, v91, v160
  v_dot2c_f32_bf16 v174, v91, v91
  v_dot2c_f32_bf16 v173, v120, v160
  v_dot2c_f32_bf16 v175, v120, v120
  v_dot2c_f32_bf16 v173, v121, v160
  v_dot2c_f32_bf16 v175, v121, v121
  ds_write_b128 v11, v[32:35] offset:0
  v_dot2c_f32_bf16 v173, v122, v160
  v_dot2c_f32_bf16 v175, v122, v122
  v_dot2c_f32_bf16 v173, v123, v160
  v_dot2c_f32_bf16 v175, v123, v123
  s_xor_b32 s87, s88, 7168
  buffer_load_dwordx4 a[156:159], v14, s[40:43], s87 offen
  v_dot2c_f32_bf16 v172, v92, v160
  v_dot2c_f32_bf16 v174, v92, v92
  v_dot2c_f32_bf16 v172, v93, v160
  v_dot2c_f32_bf16 v174, v93, v93
  ds_write_b128 v11, v[36:39] offset:1024
  v_dot2c_f32_bf16 v172, v94, v160
  v_dot2c_f32_bf16 v174, v94, v94
  v_dot2c_f32_bf16 v172, v95, v160
  v_dot2c_f32_bf16 v174, v95, v95
  v_dot2c_f32_bf16 v173, v124, v160
  v_dot2c_f32_bf16 v175, v124, v124
  v_dot2c_f32_bf16 v173, v125, v160
  v_dot2c_f32_bf16 v175, v125, v125
  ds_write_b128 v11, v[40:43] offset:2048
  s_xor_b32 s87, s88, 8192
  buffer_load_dwordx4 a[160:163], v14, s[40:43], s87 offen
  v_dot2c_f32_bf16 v173, v126, v160
  v_dot2c_f32_bf16 v175, v126, v126
  v_dot2c_f32_bf16 v173, v127, v160
  v_dot2c_f32_bf16 v175, v127, v127
  v_dot2c_f32_bf16 v172, v96, v160
  v_dot2c_f32_bf16 v174, v96, v96
  v_dot2c_f32_bf16 v172, v97, v160
  v_dot2c_f32_bf16 v174, v97, v97
  ds_write_b128 v11, v[44:47] offset:3072
  v_dot2c_f32_bf16 v172, v98, v160
  v_dot2c_f32_bf16 v174, v98, v98
  v_dot2c_f32_bf16 v172, v99, v160
  v_dot2c_f32_bf16 v174, v99, v99
  s_xor_b32 s87, s88, 9216
  buffer_load_dwordx4 a[164:167], v14, s[40:43], s87 offen
  v_dot2c_f32_bf16 v173, v128, v160
  v_dot2c_f32_bf16 v175, v128, v128
  v_dot2c_f32_bf16 v173, v129, v160
  v_dot2c_f32_bf16 v175, v129, v129
  ds_write_b128 v12, v[48:51] offset:0
  v_dot2c_f32_bf16 v173, v130, v160
  v_dot2c_f32_bf16 v175, v130, v130
  v_dot2c_f32_bf16 v173, v131, v160
  v_dot2c_f32_bf16 v175, v131, v131
  v_dot2c_f32_bf16 v172, v100, v160
  v_dot2c_f32_bf16 v174, v100, v100
  v_dot2c_f32_bf16 v172, v101, v160
  v_dot2c_f32_bf16 v174, v101, v101
  ds_write_b128 v12, v[52:55] offset:1024
  s_xor_b32 s87, s88, 10240
  buffer_load_dwordx4 a[168:171], v14, s[40:43], s87 offen
  v_dot2c_f32_bf16 v172, v102, v160
  v_dot2c_f32_bf16 v174, v102, v102
  v_dot2c_f32_bf16 v172, v103, v160
  v_dot2c_f32_bf16 v174, v103, v103
  v_dot2c_f32_bf16 v173, v132, v160
  v_dot2c_f32_bf16 v175, v132, v132
  v_dot2c_f32_bf16 v173, v133, v160
  v_dot2c_f32_bf16 v175, v133, v133
  ds_write_b128 v12, v[56:59] offset:2048
  v_dot2c_f32_bf16 v173, v134, v160
  v_dot2c_f32_bf16 v175, v134, v134
  v_dot2c_f32_bf16 v173, v135, v160
  v_dot2c_f32_bf16 v175, v135, v135
  s_xor_b32 s87, s88, 11264
  buffer_load_dwordx4 a[172:175], v14, s[40:43], s87 offen
  v_dot2c_f32_bf16 v172, v104, v160
  v_dot2c_f32_bf16 v174, v104, v104
  v_dot2c_f32_bf16 v172, v105, v160
  v_dot2c_f32_bf16 v174, v105, v105
  ds_write_b128 v12, v[60:63] offset:3072
  v_dot2c_f32_bf16 v172, v106, v160
  v_dot2c_f32_bf16 v174, v106, v106
  v_dot2c_f32_bf16 v172, v107, v160
  v_dot2c_f32_bf16 v174, v107, v107
  v_dot2c_f32_bf16 v173, v136, v160
  v_dot2c_f32_bf16 v175, v136, v136
  v_dot2c_f32_bf16 v173, v137, v160
  v_dot2c_f32_bf16 v175, v137, v137
  s_xor_b32 s87, s88, 12288
  buffer_load_dwordx4 a[176:179], v14, s[40:43], s87 offen
  v_dot2c_f32_bf16 v173, v138, v160
  v_dot2c_f32_bf16 v175, v138, v138
  v_dot2c_f32_bf16 v173, v139, v160
  v_dot2c_f32_bf16 v175, v139, v139
  v_dot2c_f32_bf16 v172, v108, v160
  v_dot2c_f32_bf16 v174, v108, v108
  v_dot2c_f32_bf16 v172, v109, v160
  v_dot2c_f32_bf16 v174, v109, v109
  v_dot2c_f32_bf16 v172, v110, v160
  v_dot2c_f32_bf16 v174, v110, v110
  v_dot2c_f32_bf16 v172, v111, v160
  v_dot2c_f32_bf16 v174, v111, v111
  s_xor_b32 s87, s88, 13312
  buffer_load_dwordx4 a[180:183], v14, s[40:43], s87 offen
  v_dot2c_f32_bf16 v173, v140, v160
  v_dot2c_f32_bf16 v175, v140, v140
  v_dot2c_f32_bf16 v173, v141, v160
  v_dot2c_f32_bf16 v175, v141, v141
  v_dot2c_f32_bf16 v173, v142, v160
  v_dot2c_f32_bf16 v175, v142, v142
  v_dot2c_f32_bf16 v173, v143, v160
  v_dot2c_f32_bf16 v175, v143, v143
  s_nop 1
  v_permlane32_swap_b32 v172, v173
  v_permlane32_swap_b32 v174, v175
  v_add_f32 v172, v172, v173
  v_add_f32 v173, v174, v175
  ds_write_b64 v184, v[172:173]
  s_waitcnt lgkmcnt(0)
  s_barrier
  ds_read_b64 v[164:165], v185 offset:0
  ds_read_b64 v[166:167], v185 offset:512
  ds_read_b64 v[168:169], v185 offset:1024
  ds_read_b64 v[170:171], v185 offset:1536
  ds_read_b128 v[80:83], v13 offset:0
  ds_read_b128 v[84:87], v13 offset:1024
  ds_read_b128 v[88:91], v13 offset:2048
  ds_read_b128 v[92:95], v13 offset:3072
  ds_read_b128 v[96:99], v13 offset:4096
  ds_read_b128 v[100:103], v13 offset:5120
  ds_read_b128 v[104:107], v13 offset:6144
  ds_read_b128 v[108:111], v13 offset:7168
  ds_read_b128 v[112:115], v13 offset:8192
  ds_read_b128 v[116:119], v13 offset:9216
  s_waitcnt lgkmcnt(10)
  v_pk_add_f32 v[164:165], v[164:165], v[166:167]
  v_pk_add_f32 v[168:169], v[168:169], v[170:171]
  v_pk_add_f32 v[164:165], v[164:165], v[168:169]
  ds_read_b128 v[120:123], v13 offset:10240
  ds_read_b128 v[124:127], v13 offset:11264
  v_mul_f32 v164, s60, v164
  v_mul_f32 v166, v164, v164
  v_fma_f32 v165, v165, s60, -v166
  v_max_f32 v165, 0, v165
  v_add_f32 v166, 0x3727c5ac, v165
  v_rsq_f32 v166, v166
  s_nop 0
  v_mul_f32 v167, v166, v166
  v_mul_f32 v167, v167, v165
  v_add_f32 v167, 0x3727c5ac, v167
  v_rsq_f32 v167, v167
  s_nop 0
  v_mul_f32 v167, v167, v166
  v_rcp_f32 v168, v167
  v_mul_f32 v169, 0xc0135761, v167
  v_mul_f32 v170, v167, v167
  v_mul_f32 v170, v170, v167
  v_mul_f32 v170, 0xbdd2d3e8, v170
  v_pk_fma_f32 v[64:65], v[164:165], v[144:145], v[64:65] op_sel:[0,0,0] op_sel_hi:[0,1,1] neg_lo:[1,0,0] neg_hi:[1,0,0]
  v_pk_fma_f32 v[66:67], v[164:165], v[146:147], v[66:67] op_sel:[0,0,0] op_sel_hi:[0,1,1] neg_lo:[1,0,0] neg_hi:[1,0,0]
  v_pk_fma_f32 v[68:69], v[164:165], v[148:149], v[68:69] op_sel:[0,0,0] op_sel_hi:[0,1,1] neg_lo:[1,0,0] neg_hi:[1,0,0]
  v_pk_fma_f32 v[70:71], v[164:165], v[150:151], v[70:71] op_sel:[0,0,0] op_sel_hi:[0,1,1] neg_lo:[1,0,0] neg_hi:[1,0,0]
  v_pk_fma_f32 v[72:73], v[164:165], v[152:153], v[72:73] op_sel:[0,0,0] op_sel_hi:[0,1,1] neg_lo:[1,0,0] neg_hi:[1,0,0]
  v_pk_fma_f32 v[74:75], v[164:165], v[154:155], v[74:75] op_sel:[0,0,0] op_sel_hi:[0,1,1] neg_lo:[1,0,0] neg_hi:[1,0,0]
  v_pk_fma_f32 v[76:77], v[164:165], v[156:157], v[76:77] op_sel:[0,0,0] op_sel_hi:[0,1,1] neg_lo:[1,0,0] neg_hi:[1,0,0]
  v_pk_fma_f32 v[78:79], v[164:165], v[158:159], v[78:79] op_sel:[0,0,0] op_sel_hi:[0,1,1] neg_lo:[1,0,0] neg_hi:[1,0,0]
  s_waitcnt lgkmcnt(10)
  v_pk_add_f32 v[64:65], v[64:65], v[80:81]
  v_pk_add_f32 v[66:67], v[66:67], v[82:83]
  v_pk_add_f32 v[68:69], v[68:69], v[84:85]
  v_pk_add_f32 v[70:71], v[70:71], v[86:87]
  s_waitcnt lgkmcnt(8)
  v_pk_add_f32 v[72:73], v[72:73], v[88:89]
  v_pk_add_f32 v[74:75], v[74:75], v[90:91]
  v_pk_add_f32 v[76:77], v[76:77], v[92:93]
  v_pk_add_f32 v[78:79], v[78:79], v[94:95]
  s_waitcnt lgkmcnt(6)
  v_pk_add_f32 v[64:65], v[64:65], v[96:97]
  v_pk_add_f32 v[66:67], v[66:67], v[98:99]
  v_pk_add_f32 v[68:69], v[68:69], v[100:101]
  v_pk_add_f32 v[70:71], v[70:71], v[102:103]
  s_waitcnt lgkmcnt(4)
  v_pk_add_f32 v[72:73], v[72:73], v[104:105]
  v_pk_add_f32 v[74:75], v[74:75], v[106:107]
  v_pk_add_f32 v[76:77], v[76:77], v[108:109]
  v_pk_add_f32 v[78:79], v[78:79], v[110:111]
  s_waitcnt lgkmcnt(2)
  v_pk_add_f32 v[64:65], v[64:65], v[112:113]
  v_pk_add_f32 v[66:67], v[66:67], v[114:115]
  v_pk_add_f32 v[68:69], v[68:69], v[116:117]
  v_pk_add_f32 v[70:71], v[70:71], v[118:119]
  s_waitcnt lgkmcnt(0)
  v_pk_add_f32 v[72:73], v[72:73], v[120:121]
  v_pk_add_f32 v[74:75], v[74:75], v[122:123]
  v_pk_add_f32 v[76:77], v[76:77], v[124:125]
  v_pk_add_f32 v[78:79], v[78:79], v[126:127]
  ds_read_b64_tr_b16 v[176:177], v187 offset:0
  ds_read_b64_tr_b16 v[178:179], v187 offset:512
  ds_read_b64_tr_b16 v[180:181], v187 offset:2048
  ds_read_b64_tr_b16 v[182:183], v187 offset:2560
  v_pk_mul_f32 v[80:81], v[64:65], v[64:65]
  v_pk_mul_f32 v[82:83], v[66:67], v[66:67]
  v_pk_mul_f32 v[84:85], v[68:69], v[68:69]
  v_pk_mul_f32 v[86:87], v[70:71], v[70:71]
  v_pk_mul_f32 v[88:89], v[72:73], v[72:73]
  v_pk_mul_f32 v[90:91], v[74:75], v[74:75]
  v_pk_mul_f32 v[92:93], v[76:77], v[76:77]
  v_pk_mul_f32 v[94:95], v[78:79], v[78:79]
  v_pk_fma_f32 v[80:81], v[80:81], v[170:171], v[168:169] op_sel:[0,0,1] op_sel_hi:[1,0,1]
  v_pk_fma_f32 v[82:83], v[82:83], v[170:171], v[168:169] op_sel:[0,0,1] op_sel_hi:[1,0,1]
  s_xor_b32 s87, s88, 14336
  buffer_load_dwordx4 a[184:187], v14, s[40:43], s87 offen
  v_pk_fma_f32 v[84:85], v[84:85], v[170:171], v[168:169] op_sel:[0,0,1] op_sel_hi:[1,0,1]
  v_pk_fma_f32 v[86:87], v[86:87], v[170:171], v[168:169] op_sel:[0,0,1] op_sel_hi:[1,0,1]
  v_pk_fma_f32 v[88:89], v[88:89], v[170:171], v[168:169] op_sel:[0,0,1] op_sel_hi:[1,0,1]
  v_pk_fma_f32 v[90:91], v[90:91], v[170:171], v[168:169] op_sel:[0,0,1] op_sel_hi:[1,0,1]
  v_pk_fma_f32 v[92:93], v[92:93], v[170:171], v[168:169] op_sel:[0,0,1] op_sel_hi:[1,0,1]
  v_pk_fma_f32 v[94:95], v[94:95], v[170:171], v[168:169] op_sel:[0,0,1] op_sel_hi:[1,0,1]
  v_pk_mul_f32 v[80:81], v[80:81], v[64:65]
  v_pk_mul_f32 v[82:83], v[82:83], v[66:67]
  v_pk_mul_f32 v[84:85], v[84:85], v[68:69]
  v_pk_mul_f32 v[86:87], v[86:87], v[70:71]
  s_xor_b32 s87, s88, 15360
  buffer_load_dwordx4 a[188:191], v14, s[40:43], s87 offen
  v_pk_mul_f32 v[88:89], v[88:89], v[72:73]
  v_pk_mul_f32 v[90:91], v[90:91], v[74:75]
  v_pk_mul_f32 v[92:93], v[92:93], v[76:77]
  v_pk_mul_f32 v[94:95], v[94:95], v[78:79]
  v_exp_f32 v80, v80
  v_exp_f32 v81, v81
  v_exp_f32 v82, v82
  v_exp_f32 v83, v83
  v_exp_f32 v84, v84
  v_exp_f32 v85, v85
  s_xor_b32 s87, s75, 0
  buffer_load_dwordx4 a[192:195], v14, s[40:43], s87 offen
  v_exp_f32 v86, v86
  v_exp_f32 v87, v87
  v_exp_f32 v88, v88
  v_exp_f32 v89, v89
  v_exp_f32 v90, v90
  v_exp_f32 v91, v91
  v_exp_f32 v92, v92
  v_exp_f32 v93, v93
  v_exp_f32 v94, v94
  v_exp_f32 v95, v95
  s_xor_b32 s87, s75, 1024
  buffer_load_dwordx4 a[196:199], v14, s[40:43], s87 offen
  v_pk_fma_f32 v[80:81], v[80:81], v[168:169], v[168:169] op_sel:[0,0,0] op_sel_hi:[1,0,0]
  v_pk_fma_f32 v[82:83], v[82:83], v[168:169], v[168:169] op_sel:[0,0,0] op_sel_hi:[1,0,0]
  v_pk_fma_f32 v[84:85], v[84:85], v[168:169], v[168:169] op_sel:[0,0,0] op_sel_hi:[1,0,0]
  v_pk_fma_f32 v[86:87], v[86:87], v[168:169], v[168:169] op_sel:[0,0,0] op_sel_hi:[1,0,0]
  v_pk_fma_f32 v[88:89], v[88:89], v[168:169], v[168:169] op_sel:[0,0,0] op_sel_hi:[1,0,0]
  v_pk_fma_f32 v[90:91], v[90:91], v[168:169], v[168:169] op_sel:[0,0,0] op_sel_hi:[1,0,0]
  v_pk_fma_f32 v[92:93], v[92:93], v[168:169], v[168:169] op_sel:[0,0,0] op_sel_hi:[1,0,0]
  v_pk_fma_f32 v[94:95], v[94:95], v[168:169], v[168:169] op_sel:[0,0,0] op_sel_hi:[1,0,0]
  v_rcp_f32 v80, v80
  v_rcp_f32 v81, v81
  v_rcp_f32 v82, v82
  v_rcp_f32 v83, v83
  v_rcp_f32 v84, v84
  v_rcp_f32 v85, v85
  v_rcp_f32 v86, v86
  v_rcp_f32 v87, v87
  v_rcp_f32 v88, v88
  v_rcp_f32 v89, v89
  v_rcp_f32 v90, v90
  v_rcp_f32 v91, v91
  v_rcp_f32 v92, v92
  v_rcp_f32 v93, v93
  v_rcp_f32 v94, v94
  v_rcp_f32 v95, v95
  v_pk_mul_f32 v[64:65], v[64:65], v[80:81]
  v_pk_mul_f32 v[66:67], v[66:67], v[82:83]
  v_pk_mul_f32 v[68:69], v[68:69], v[84:85]
  v_pk_mul_f32 v[70:71], v[70:71], v[86:87]
  v_pk_mul_f32 v[72:73], v[72:73], v[88:89]
  v_pk_mul_f32 v[74:75], v[74:75], v[90:91]
  v_pk_mul_f32 v[76:77], v[76:77], v[92:93]
  v_pk_mul_f32 v[78:79], v[78:79], v[94:95]
  v_cvt_pk_bf16_f32 v96, v64, v65
  v_cvt_pk_bf16_f32 v97, v66, v67
  v_cvt_pk_bf16_f32 v98, v68, v69
  v_cvt_pk_bf16_f32 v99, v70, v71
  v_cvt_pk_bf16_f32 v100, v72, v73
  v_cvt_pk_bf16_f32 v101, v74, v75
  v_cvt_pk_bf16_f32 v102, v76, v77
  v_cvt_pk_bf16_f32 v103, v78, v79
  v_min_u32 v96, -2, v96
  v_min_u32 v97, -2, v97
  v_min_u32 v98, -2, v98
  v_min_u32 v99, -2, v99
  v_min_u32 v100, -2, v100
  v_min_u32 v101, -2, v101
  v_min_u32 v102, -2, v102
  v_min_u32 v103, -2, v103
  buffer_store_dwordx4 v[96:99], v14, s[32:35], s71 offen sc1
  buffer_store_dwordx4 v[100:103], v14, s[32:35], s71 offen offset:1024 sc1
  s_xor_b32 s87, s75, 2048
  buffer_load_dwordx4 a[200:203], v14, s[40:43], s87 offen
  s_xor_b32 s87, s75, 3072
  buffer_load_dwordx4 a[204:207], v14, s[40:43], s87 offen
  s_xor_b32 s87, s75, 4096
  buffer_load_dwordx4 a[208:211], v14, s[40:43], s87 offen
  s_xor_b32 s87, s75, 5120
  buffer_load_dwordx4 a[212:215], v14, s[40:43], s87 offen
  s_waitcnt lgkmcnt(0)
  v_lshlrev_b32 v144, 16, v176
  v_and_b32 v145, s61, v176
  v_lshlrev_b32 v146, 16, v177
  v_and_b32 v147, s61, v177
  v_lshlrev_b32 v148, 16, v178
  v_and_b32 v149, s61, v178
  v_lshlrev_b32 v150, 16, v179
  v_and_b32 v151, s61, v179
  v_lshlrev_b32 v152, 16, v180
  v_and_b32 v153, s61, v180
  v_lshlrev_b32 v154, 16, v181
  v_and_b32 v155, s61, v181
  v_lshlrev_b32 v156, 16, v182
  v_and_b32 v157, s61, v182
  v_lshlrev_b32 v158, 16, v183
  v_and_b32 v159, s61, v183
  v_pk_add_f32 v[176:177], v[144:145], v[164:165] op_sel:[0,0] op_sel_hi:[1,0] neg_lo:[0,1] neg_hi:[0,1]
  v_pk_add_f32 v[178:179], v[146:147], v[164:165] op_sel:[0,0] op_sel_hi:[1,0] neg_lo:[0,1] neg_hi:[0,1]
  v_pk_add_f32 v[180:181], v[148:149], v[164:165] op_sel:[0,0] op_sel_hi:[1,0] neg_lo:[0,1] neg_hi:[0,1]
  v_pk_add_f32 v[182:183], v[150:151], v[164:165] op_sel:[0,0] op_sel_hi:[1,0] neg_lo:[0,1] neg_hi:[0,1]
  v_pk_add_f32 v[184:185], v[152:153], v[164:165] op_sel:[0,0] op_sel_hi:[1,0] neg_lo:[0,1] neg_hi:[0,1]
  v_pk_add_f32 v[186:187], v[154:155], v[164:165] op_sel:[0,0] op_sel_hi:[1,0] neg_lo:[0,1] neg_hi:[0,1]
  v_pk_add_f32 v[188:189], v[156:157], v[164:165] op_sel:[0,0] op_sel_hi:[1,0] neg_lo:[0,1] neg_hi:[0,1]
  v_pk_add_f32 v[190:191], v[158:159], v[164:165] op_sel:[0,0] op_sel_hi:[1,0] neg_lo:[0,1] neg_hi:[0,1]
  v_pk_mul_f32 v[176:177], v[176:177], v[166:167] op_sel:[0,0] op_sel_hi:[1,0]
  v_pk_mul_f32 v[178:179], v[178:179], v[166:167] op_sel:[0,0] op_sel_hi:[1,0]
  v_pk_mul_f32 v[180:181], v[180:181], v[166:167] op_sel:[0,0] op_sel_hi:[1,0]
  v_pk_mul_f32 v[182:183], v[182:183], v[166:167] op_sel:[0,0] op_sel_hi:[1,0]
  v_pk_mul_f32 v[184:185], v[184:185], v[166:167] op_sel:[0,0] op_sel_hi:[1,0]
  v_pk_mul_f32 v[186:187], v[186:187], v[166:167] op_sel:[0,0] op_sel_hi:[1,0]
  v_pk_mul_f32 v[188:189], v[188:189], v[166:167] op_sel:[0,0] op_sel_hi:[1,0]
  v_pk_mul_f32 v[190:191], v[190:191], v[166:167] op_sel:[0,0] op_sel_hi:[1,0]
  s_add_u32 s59, s79, 0x1452000
  s_add_u32 s58, s72, 0x1452000
  v_and_b32 v4, 1, v1
  v_lshlrev_b32 v4, 3, v4
  s_lshl_b32 s56, s66, 15
  s_add_u32 s64, s56, s70
  s_add_u32 s64, s64, 0x800000
  s_add_u32 s44, s30, 0x600000
  s_addc_u32 s45, s31, 0
  s_mov_b32 s46, 0x200000
  s_mov_b32 s47, 0x20000
  s_lshl_b32 s56, s48, 13
  s_mov_b32 s57, s56
  s_lshl_b32 s53, s48, 3
  s_lshr_b32 s53, 0xfe02ff01, s53
  s_sext_i32_i8 s53, s53
  v_and_b32 v7, 31, v1
  v_subrev_u32 v7, s53, v7
  v_lshrrev_b32 v172, 5, v1
  v_lshlrev_b32 v172, 9, v172
  s_xor_b32 s54, s66, 1
  s_lshl_b32 s54, s54, 5
  v_add_u32 v173, s54, v7
  v_lshrrev_b32 v174, 5, v173
  v_lshl_add_u32 v174, v174, 15, v172
  v_and_b32 v173, 31, v173
  v_lshl_add_u32 v8, v173, 4, v174
  s_xor_b32 s54, s66, 0
  s_lshl_b32 s54, s54, 5
  v_add_u32 v173, s54, v7
  v_lshrrev_b32 v174, 5, v173
  v_lshl_add_u32 v174, v174, 15, v172
  v_and_b32 v173, 31, v173
  v_lshl_add_u32 v9, v173, 4, v174
  s_lshl_b32 s54, s68, 13
  s_lshr_b32 s55, s70, 2
  s_add_u32 s54, s54, s55
  s_lshl_b32 s55, s51, 8
  s_add_u32 s54, s54, s55
  s_add_u32 s65, s54, 0x1410000
  v_lshlrev_b32 v0, 3, v1
  s_waitcnt vmcnt(4)
  s_barrier
  s_cmp_lg_u32 s48, 0
  s_cbranch_scc1 Lsig4
  s_mov_b64 exec, 1
  buffer_store_dwordx2 v[2:3], off, s[32:35], s59
  s_add_u32 s83, s59, 0x10000
  buffer_store_dwordx2 v[2:3], off, s[32:35], s83 sc1
  s_mov_b64 exec, -1
Lsig4:
  s_mov_b32 s82, 0
  buffer_load_dwordx2 v[16:17], v4, s[32:35], s58 offen sc1
Lpoll5:
  s_waitcnt vmcnt(0)
  v_cmp_ne_u64 vcc, s[80:81], v[16:17]
  s_cbranch_vccz Lpolld5
  s_cmp_lg_u32 s82, 32
  s_cbranch_scc1 Lpollp5
  s_add_u32 s83, s59, 0x10000
  s_mov_b64 exec, 1
  buffer_store_dwordx2 v[2:3], off, s[32:35], s83 sc1
  s_mov_b64 exec, -1
Lpollp5:
  s_cmp_lt_u32 s82, 32
  s_cselect_b32 s83, 0, 0x10000
  s_add_u32 s83, s83, s58
  buffer_load_dwordx2 v[16:17], v4, s[32:35], s83 offen sc1
  s_add_u32 s82, s82, 1
  s_cmp_gt_u32 s82, 0x20000
  s_cbranch_scc1 Lend
  s_branch Lpoll5
Lpolld5:
  s_add_u32 s93, s57, 0
  buffer_load_dwordx4 v[80:83], v8, s[44:47], s93 offen offset:0 sc1
  buffer_load_dwordx4 v[84:87], v8, s[44:47], s93 offen offset:1024 sc1
  buffer_load_dwordx4 v[88:91], v8, s[44:47], s93 offen offset:2048 sc1
  buffer_load_dwordx4 v[92:95], v8, s[44:47], s93 offen offset:3072 sc1
  s_add_u32 s93, s57, 4096
  buffer_load_dwordx4 v[96:99], v8, s[44:47], s93 offen offset:0 sc1
  buffer_load_dwordx4 v[100:103], v8, s[44:47], s93 offen offset:1024 sc1
  buffer_load_dwordx4 v[104:107], v8, s[44:47], s93 offen offset:2048 sc1
  buffer_load_dwordx4 v[108:111], v8, s[44:47], s93 offen offset:3072 sc1
  s_waitcnt vmcnt(7)
  v_mfma_f32_32x32x16_bf16 v[16:31], a[64:67], v[80:83], 0
  s_add_u32 s93, s56, 0
  buffer_load_dwordx4 v[112:115], v9, s[44:47], s93 offen offset:0 sc1
  v_mfma_f32_32x32x16_bf16 v[32:47], a[68:71], v[80:83], 0
  s_waitcnt vmcnt(7)
  v_mfma_f32_32x32x16_bf16 v[16:31], a[72:75], v[84:87], v[16:31]
  buffer_load_dwordx4 v[116:119], v9, s[44:47], s93 offen offset:1024 sc1
  v_mfma_f32_32x32x16_bf16 v[32:47], a[76:79], v[84:87], v[32:47]
  s_waitcnt vmcnt(7)
  v_mfma_f32_32x32x16_bf16 v[16:31], a[80:83], v[88:91], v[16:31]
  buffer_load_dwordx4 v[120:123], v9, s[44:47], s93 offen offset:2048 sc1
  v_mfma_f32_32x32x16_bf16 v[32:47], a[84:87], v[88:91], v[32:47]
  s_waitcnt vmcnt(7)
  v_mfma_f32_32x32x16_bf16 v[16:31], a[88:91], v[92:95], v[16:31]
  buffer_load_dwordx4 v[124:127], v9, s[44:47], s93 offen offset:3072 sc1
  v_mfma_f32_32x32x16_bf16 v[32:47], a[92:95], v[92:95], v[32:47]
  s_waitcnt vmcnt(7)
  v_mfma_f32_32x32x16_bf16 v[16:31], a[96:99], v[96:99], v[16:31]
  s_add_u32 s93, s56, 4096
  buffer_load_dwordx4 v[128:131], v9, s[44:47], s93 offen offset:0 sc1
  v_mfma_f32_32x32x16_bf16 v[32:47], a[100:103], v[96:99], v[32:47]
  s_waitcnt vmcnt(7)
  v_mfma_f32_32x32x16_bf16 v[16:31], a[104:107], v[100:103], v[16:31]
  buffer_load_dwordx4 v[132:135], v9, s[44:47], s93 offen offset:1024 sc1
  v_mfma_f32_32x32x16_bf16 v[32:47], a[108:111], v[100:103], v[32:47]
  s_waitcnt vmcnt(7)
  v_mfma_f32_32x32x16_bf16 v[16:31], a[112:115], v[104:107], v[16:31]
  buffer_load_dwordx4 v[136:139], v9, s[44:47], s93 offen offset:2048 sc1
  v_mfma_f32_32x32x16_bf16 v[32:47], a[116:119], v[104:107], v[32:47]
  s_waitcnt vmcnt(7)
  v_mfma_f32_32x32x16_bf16 v[16:31], a[120:123], v[108:111], v[16:31]
  buffer_load_dwordx4 v[140:143], v9, s[44:47], s93 offen offset:3072 sc1
  v_mfma_f32_32x32x16_bf16 v[32:47], a[124:127], v[108:111], v[32:47]
  s_xor_b32 s87, s75, 6144
  buffer_load_dwordx4 a[216:219], v14, s[40:43], s87 offen
  s_mov_b32 s82, 0
Lhalo:
  v_mov_b32 v7, 0
  s_waitcnt vmcnt(8)
  v_mfma_f32_32x32x16_bf16 v[48:63], a[64:67], v[112:115], 0
  v_max3_u32 v7, v7, v112, v113
  s_xor_b32 s87, s75, 7168
  buffer_load_dwordx4 a[220:223], v14, s[40:43], s87 offen
  v_mfma_f32_32x32x16_bf16 v[64:79], a[68:71], v[112:115], 0
  v_max3_u32 v7, v7, v114, v115
  s_xor_b32 s87, s75, 8192
  buffer_load_dwordx4 a[224:227], v14, s[40:43], s87 offen
  s_waitcnt vmcnt(9)
  v_mfma_f32_32x32x16_bf16 v[48:63], a[72:75], v[116:119], v[48:63]
  v_max3_u32 v7, v7, v116, v117
  s_xor_b32 s87, s75, 9216
  buffer_load_dwordx4 a[228:231], v14, s[40:43], s87 offen
  v_mfma_f32_32x32x16_bf16 v[64:79], a[76:79], v[116:119], v[64:79]
  v_max3_u32 v7, v7, v118, v119
  s_xor_b32 s87, s75, 10240
  buffer_load_dwordx4 a[232:235], v14, s[40:43], s87 offen
  ds_write_b128 v10, v[16:19] offset:0
  s_waitcnt vmcnt(10)
  v_mfma_f32_32x32x16_bf16 v[48:63], a[80:83], v[120:123], v[48:63]
  v_max3_u32 v7, v7, v120, v121
  s_xor_b32 s87, s75, 11264
  buffer_load_dwordx4 a[236:239], v14, s[40:43], s87 offen
  v_mfma_f32_32x32x16_bf16 v[64:79], a[84:87], v[120:123], v[64:79]
  v_max3_u32 v7, v7, v122, v123
  s_xor_b32 s87, s75, 12288
  buffer_load_dwordx4 a[240:243], v14, s[40:43], s87 offen
  ds_write_b128 v10, v[20:23] offset:1024
  s_waitcnt vmcnt(11)
  v_mfma_f32_32x32x16_bf16 v[48:63], a[88:91], v[124:127], v[48:63]
  v_max3_u32 v7, v7, v124, v125
  s_xor_b32 s87, s75, 13312
  buffer_load_dwordx4 a[244:247], v14, s[40:43], s87 offen
  v_mfma_f32_32x32x16_bf16 v[64:79], a[92:95], v[124:127], v[64:79]
  v_max3_u32 v7, v7, v126, v127
  s_xor_b32 s87, s75, 14336
  buffer_load_dwordx4 a[248:251], v14, s[40:43], s87 offen
  ds_write_b128 v10, v[24:27] offset:2048
  s_waitcnt vmcnt(12)
  v_mfma_f32_32x32x16_bf16 v[48:63], a[96:99], v[128:131], v[48:63]
  v_max3_u32 v7, v7, v128, v129
  s_xor_b32 s87, s75, 15360
  buffer_load_dwordx4 a[252:255], v14, s[40:43], s87 offen
  v_mfma_f32_32x32x16_bf16 v[64:79], a[100:103], v[128:131], v[64:79]
  v_max3_u32 v7, v7, v130, v131
  s_xor_b32 s87, s74, 0
  buffer_load_dwordx4 v[192:195], v14, s[40:43], s87 offen
  ds_write_b128 v10, v[28:31] offset:3072
  s_waitcnt vmcnt(13)
  v_mfma_f32_32x32x16_bf16 v[48:63], a[104:107], v[132:135], v[48:63]
  v_max3_u32 v7, v7, v132, v133
  s_xor_b32 s87, s74, 1024
  buffer_load_dwordx4 v[196:199], v14, s[40:43], s87 offen
  v_mfma_f32_32x32x16_bf16 v[64:79], a[108:111], v[132:135], v[64:79]
  v_max3_u32 v7, v7, v134, v135
  s_xor_b32 s87, s74, 2048
  buffer_load_dwordx4 v[200:203], v14, s[40:43], s87 offen
  ds_write_b128 v11, v[32:35] offset:0
  s_waitcnt vmcnt(14)
  v_mfma_f32_32x32x16_bf16 v[48:63], a[112:115], v[136:139], v[48:63]
  v_max3_u32 v7, v7, v136, v137
  s_xor_b32 s87, s74, 3072
  buffer_load_dwordx4 v[204:207], v14, s[40:43], s87 offen
  v_mfma_f32_32x32x16_bf16 v[64:79], a[116:119], v[136:139], v[64:79]
  v_max3_u32 v7, v7, v138, v139
  s_xor_b32 s87, s74, 4096
  buffer_load_dwordx4 v[208:211], v14, s[40:43], s87 offen
  ds_write_b128 v11, v[36:39] offset:1024
  s_waitcnt vmcnt(15)
  v_mfma_f32_32x32x16_bf16 v[48:63], a[120:123], v[140:143], v[48:63]
  v_max3_u32 v7, v7, v140, v141
  v_mfma_f32_32x32x16_bf16 v[64:79], a[124:127], v[140:143], v[64:79]
  v_max3_u32 v7, v7, v142, v143
  s_xor_b32 s87, s74, 5120
  buffer_load_dwordx4 v[212:215], v14, s[40:43], s87 offen
  ds_write_b128 v11, v[40:43] offset:2048
  ds_write_b128 v11, v[44:47] offset:3072
  v_cmp_eq_u32 vcc, -1, v7
  s_cbranch_vccz Lhalook
  s_add_u32 s93, s56, 0
  buffer_load_dwordx4 v[112:115], v9, s[44:47], s93 offen offset:0 sc1
  buffer_load_dwordx4 v[116:119], v9, s[44:47], s93 offen offset:1024 sc1
  buffer_load_dwordx4 v[120:123], v9, s[44:47], s93 offen offset:2048 sc1
  buffer_load_dwordx4 v[124:127], v9, s[44:47], s93 offen offset:3072 sc1
  s_add_u32 s93, s56, 4096
  buffer_load_dwordx4 v[128:131], v9, s[44:47], s93 offen offset:0 sc1
  buffer_load_dwordx4 v[132:135], v9, s[44:47], s93 offen offset:1024 sc1
  buffer_load_dwordx4 v[136:139], v9, s[44:47], s93 offen offset:2048 sc1
  buffer_load_dwordx4 v[140:143], v9, s[44:47], s93 offen offset:3072 sc1
  s_add_u32 s82, s82, 1
  s_cmp_gt_u32 s82, 0x8000
  s_cbranch_scc1 Lend
  s_waitcnt vmcnt(0)
  s_branch Lhalo
Lhalook:
  s_nop 2
  ds_write_b128 v12, v[48:51] offset:0
  ds_write_b128 v12, v[52:55] offset:1024
  ds_write_b128 v12, v[56:59] offset:2048
  ds_write_b128 v12, v[60:63] offset:3072
  s_waitcnt lgkmcnt(0)
  s_barrier
  ds_read_b128 v[80:83], v13 offset:0
  ds_read_b128 v[84:87], v13 offset:1024
  ds_read_b128 v[88:91], v13 offset:2048
  ds_read_b128 v[92:95], v13 offset:3072
  ds_read_b128 v[96:99], v13 offset:4096
  ds_read_b128 v[100:103], v13 offset:5120
  ds_read_b128 v[104:107], v13 offset:6144
  ds_read_b128 v[108:111], v13 offset:7168
  ds_read_b128 v[112:115], v13 offset:8192
  ds_read_b128 v[116:119], v13 offset:9216
  ds_read_b128 v[120:123], v13 offset:10240
  ds_read_b128 v[124:127], v13 offset:11264
  v_pk_add_f32 v[64:65], v[64:65], v[176:177]
  v_pk_add_f32 v[66:67], v[66:67], v[178:179]
  v_pk_add_f32 v[68:69], v[68:69], v[180:181]
  v_pk_add_f32 v[70:71], v[70:71], v[182:183]
  v_pk_add_f32 v[72:73], v[72:73], v[184:185]
  v_pk_add_f32 v[74:75], v[74:75], v[186:187]
  v_pk_add_f32 v[76:77], v[76:77], v[188:189]
  v_pk_add_f32 v[78:79], v[78:79], v[190:191]
  s_waitcnt lgkmcnt(10)
  v_pk_add_f32 v[64:65], v[64:65], v[80:81]
  v_pk_add_f32 v[66:67], v[66:67], v[82:83]
  v_pk_add_f32 v[68:69], v[68:69], v[84:85]
  v_pk_add_f32 v[70:71], v[70:71], v[86:87]
  s_waitcnt lgkmcnt(8)
  v_pk_add_f32 v[72:73], v[72:73], v[88:89]
  v_pk_add_f32 v[74:75], v[74:75], v[90:91]
  v_pk_add_f32 v[76:77], v[76:77], v[92:93]
  v_pk_add_f32 v[78:79], v[78:79], v[94:95]
  s_waitcnt lgkmcnt(6)
  v_pk_add_f32 v[64:65], v[64:65], v[96:97]
  v_pk_add_f32 v[66:67], v[66:67], v[98:99]
  v_pk_add_f32 v[68:69], v[68:69], v[100:101]
  v_pk_add_f32 v[70:71], v[70:71], v[102:103]
  s_waitcnt lgkmcnt(4)
  v_pk_add_f32 v[72:73], v[72:73], v[104:105]
  v_pk_add_f32 v[74:75], v[74:75], v[106:107]
  v_pk_add_f32 v[76:77], v[76:77], v[108:109]
  v_pk_add_f32 v[78:79], v[78:79], v[110:111]
  s_waitcnt lgkmcnt(2)
  v_pk_add_f32 v[64:65], v[64:65], v[112:113]
  v_pk_add_f32 v[66:67], v[66:67], v[114:115]
  v_pk_add_f32 v[68:69], v[68:69], v[116:117]
  v_pk_add_f32 v[70:71], v[70:71], v[118:119]
  s_waitcnt lgkmcnt(0)
  v_pk_add_f32 v[72:73], v[72:73], v[120:121]
  v_pk_add_f32 v[74:75], v[74:75], v[122:123]
  v_pk_add_f32 v[76:77], v[76:77], v[124:125]
  v_pk_add_f32 v[78:79], v[78:79], v[126:127]
  v_cvt_pk_bf16_f32 v96, v64, v65
  v_cvt_pk_bf16_f32 v97, v66, v67
  v_cvt_pk_bf16_f32 v98, v68, v69
  v_cvt_pk_bf16_f32 v99, v70, v71
  v_cvt_pk_bf16_f32 v100, v72, v73
  v_cvt_pk_bf16_f32 v101, v74, v75
  v_cvt_pk_bf16_f32 v102, v76, v77
  v_cvt_pk_bf16_f32 v103, v78, v79
  buffer_store_dwordx4 v[96:99], v14, s[32:35], s64 offen sc1
  buffer_store_dwordx4 v[100:103], v14, s[32:35], s64 offen offset:1024 sc1
  v_mov_b32 v104, 0
  v_mov_b32 v105, 0
  v_dot2c_f32_bf16 v104, v96, v160
  v_dot2c_f32_bf16 v105, v96, v96
  v_dot2c_f32_bf16 v104, v97, v160
  v_dot2c_f32_bf16 v105, v97, v97
  v_dot2c_f32_bf16 v104, v98, v160
  v_dot2c_f32_bf16 v105, v98, v98
  v_dot2c_f32_bf16 v104, v99, v160
  v_dot2c_f32_bf16 v105, v99, v99
  v_dot2c_f32_bf16 v104, v100, v160
  v_dot2c_f32_bf16 v105, v100, v100
  v_dot2c_f32_bf16 v104, v101, v160
  v_dot2c_f32_bf16 v105, v101, v101
  v_dot2c_f32_bf16 v104, v102, v160
  v_dot2c_f32_bf16 v105, v102, v102
  v_dot2c_f32_bf16 v104, v103, v160
  v_dot2c_f32_bf16 v105, v103, v103
  s_nop 1
  v_mov_b32 v106, v104
  v_mov_b32 v107, v105
  s_nop 0
  v_permlane32_swap_b32 v104, v106
  v_permlane32_swap_b32 v105, v107
  v_pk_add_f32 v[104:105], v[104:105], v[106:107]
  s_mov_b32 exec_hi, 0
  buffer_store_dwordx2 v[104:105], v0, s[32:35], s65 offen sc1
  s_mov_b32 exec_hi, -1
  s_xor_b32 s87, s74, 6144
  buffer_load_dwordx4 v[216:219], v14, s[40:43], s87 offen
  s_xor_b32 s87, s74, 7168
  buffer_load_dwordx4 v[220:223], v14, s[40:43], s87 offen
  s_xor_b32 s87, s74, 8192
  buffer_load_dwordx4 v[224:227], v14, s[40:43], s87 offen
  s_xor_b32 s87, s74, 9216
  buffer_load_dwordx4 v[228:231], v14, s[40:43], s87 offen
  s_xor_b32 s87, s74, 10240
  buffer_load_dwordx4 v[232:235], v14, s[40:43], s87 offen
  s_xor_b32 s87, s74, 11264
  buffer_load_dwordx4 v[236:239], v14, s[40:43], s87 offen
  s_xor_b32 s87, s74, 12288
  buffer_load_dwordx4 v[240:243], v14, s[40:43], s87 offen
  s_xor_b32 s87, s74, 13312
  buffer_load_dwordx4 v[244:247], v14, s[40:43], s87 offen
  s_xor_b32 s87, s74, 14336
  buffer_load_dwordx4 v[248:251], v14, s[40:43], s87 offen
  s_xor_b32 s87, s74, 15360
  buffer_load_dwordx4 v[252:255], v14, s[40:43], s87 offen
  v_lshlrev_b32 v80, 16, v96
  v_and_b32 v81, s61, v96
  v_lshlrev_b32 v82, 16, v97
  v_and_b32 v83, s61, v97
  v_lshlrev_b32 v84, 16, v98
  v_and_b32 v85, s61, v98
  v_lshlrev_b32 v86, 16, v99
  v_and_b32 v87, s61, v99
  v_lshlrev_b32 v88, 16, v100
  v_and_b32 v89, s61, v100
  v_lshlrev_b32 v90, 16, v101
  v_and_b32 v91, s61, v101
  v_lshlrev_b32 v92, 16, v102
  v_and_b32 v93, s61, v102
  v_lshlrev_b32 v94, 16, v103
  v_and_b32 v95, s61, v103
  v_pk_add_f32 v[128:129], v[144:145], v[80:81]
  v_pk_add_f32 v[130:131], v[146:147], v[82:83]
  v_pk_add_f32 v[132:133], v[148:149], v[84:85]
  v_pk_add_f32 v[134:135], v[150:151], v[86:87]
  v_pk_add_f32 v[136:137], v[152:153], v[88:89]
  v_pk_add_f32 v[138:139], v[154:155], v[90:91]
  v_pk_add_f32 v[140:141], v[156:157], v[92:93]
  v_pk_add_f32 v[142:143], v[158:159], v[94:95]
  s_add_u32 s59, s79, 0x1454000
  s_add_u32 s58, s72, 0x1454000
  s_lshl_b32 s64, s48, 13
  s_lshl_b32 s65, s68, 16
  s_add_u32 s65, s65, s64
  s_add_u32 s65, s65, 0x800000
  s_lshl_b32 s53, s92, 1
  s_xor_b32 s64, s64, s53
  s_lshl_b32 s67, s68, 13
  s_lshl_b32 s54, s48, 11
  s_add_u32 s67, s67, s54
  s_add_u32 s67, s67, 0x1410000
  v_lshlrev_b32 v8, 9, v6
  v_lshl_add_u32 v8, v5, 4, v8
  v_add_u32 v9, 0x8000, v8
  s_mul_i32 s74, s69, 176128
  s_mul_i32 s53, s48, 45056
  s_add_u32 s74, s74, s53
  s_add_u32 s75, s74, 40960
  s_cmp_eq_u32 s48, 3
  s_cselect_b32 s75, 0x400000, s75
  s_lshl_b32 s53, s52, 10
  v_add_u32 v113, s53, v14
  v_xor_b32 v112, 0x400, v113
  s_add_u32 s44, s30, 0xa00000
  s_addc_u32 s45, s31, 0
  s_mov_b32 s46, 0x580000
  s_mov_b32 s47, 0x20000
  s_lshl_b32 s53, s68, 1
  s_mul_i32 s53, s53, 90112
  s_lshl_b32 s54, s73, 10
  s_add_u32 s56, s53, s54
  s_add_u32 s57, s56, 90112
  s_cmp_eq_u32 s48, 3
  s_cselect_b32 s76, 0x580000, s56
  s_cselect_b32 s77, 0x580000, s57
  s_lshl_b32 s53, s48, 3
  s_add_u32 s53, s53, 114688
  v_lshlrev_b32 v115, 5, v1
  v_add_u32 v114, s53, v115
  v_add_u32 v115, 114688, v115
  s_mov_b32 m0, s64
  s_lshr_b32 s92, s92, 0
  s_lshl_b32 s89, s92, 1
  s_waitcnt vmcnt(10)
  s_barrier
  s_cmp_lg_u32 s48, 0
  s_cbranch_scc1 Lsig6
  s_mov_b64 exec, 1
  buffer_store_dwordx2 v[2:3], off, s[32:35], s59
  s_add_u32 s83, s59, 0x10000
  buffer_store_dwordx2 v[2:3], off, s[32:35], s83 sc1
  s_mov_b64 exec, -1
Lsig6:
  s_mov_b32 s82, 0
  buffer_load_dwordx2 v[16:17], v4, s[32:35], s58 offen sc1
  v_mfma_f32_16x16x32_bf16 v[120:123], a[128:131], v[160:163], 0
  v_mfma_f32_16x16x32_bf16 v[120:123], a[132:135], v[160:163], v[120:123]
  v_mfma_f32_16x16x32_bf16 v[120:123], a[136:139], v[160:163], v[120:123]
  v_mfma_f32_16x16x32_bf16 v[120:123], a[140:143], v[160:163], v[120:123]
  v_mfma_f32_16x16x32_bf16 v[120:123], a[144:147], v[160:163], v[120:123]
  v_mfma_f32_16x16x32_bf16 v[120:123], a[148:151], v[160:163], v[120:123]
  v_mfma_f32_16x16x32_bf16 v[120:123], a[152:155], v[160:163], v[120:123]
  v_mfma_f32_16x16x32_bf16 v[120:123], a[156:159], v[160:163], v[120:123]
  v_mfma_f32_16x16x32_bf16 v[120:123], a[160:163], v[160:163], v[120:123]
  v_mfma_f32_16x16x32_bf16 v[120:123], a[164:167], v[160:163], v[120:123]
  v_mfma_f32_16x16x32_bf16 v[120:123], a[168:171], v[160:163], v[120:123]
  v_mfma_f32_16x16x32_bf16 v[120:123], a[172:175], v[160:163], v[120:123]
  v_mfma_f32_16x16x32_bf16 v[120:123], a[176:179], v[160:163], v[120:123]
  v_mfma_f32_16x16x32_bf16 v[120:123], a[180:183], v[160:163], v[120:123]
  v_mfma_f32_16x16x32_bf16 v[120:123], a[184:187], v[160:163], v[120:123]
  v_mfma_f32_16x16x32_bf16 v[120:123], a[188:191], v[160:163], v[120:123]
  v_mfma_f32_16x16x32_bf16 v[124:127], a[192:195], v[160:163], 0
  v_mfma_f32_16x16x32_bf16 v[124:127], a[196:199], v[160:163], v[124:127]
  v_mfma_f32_16x16x32_bf16 v[124:127], a[200:203], v[160:163], v[124:127]
  v_mfma_f32_16x16x32_bf16 v[124:127], a[204:207], v[160:163], v[124:127]
  v_mfma_f32_16x16x32_bf16 v[124:127], a[208:211], v[160:163], v[124:127]
  v_mfma_f32_16x16x32_bf16 v[124:127], a[212:215], v[160:163], v[124:127]
  v_mfma_f32_16x16x32_bf16 v[124:127], a[216:219], v[160:163], v[124:127]
  v_mfma_f32_16x16x32_bf16 v[124:127], a[220:223], v[160:163], v[124:127]
  v_mfma_f32_16x16x32_bf16 v[124:127], a[224:227], v[160:163], v[124:127]
  v_mfma_f32_16x16x32_bf16 v[124:127], a[228:231], v[160:163], v[124:127]
  v_mfma_f32_16x16x32_bf16 v[124:127], a[232:235], v[160:163], v[124:127]
  v_mfma_f32_16x16x32_bf16 v[124:127], a[236:239], v[160:163], v[124:127]
  v_mfma_f32_16x16x32_bf16 v[124:127], a[240:243], v[160:163], v[124:127]
  v_mfma_f32_16x16x32_bf16 v[124:127], a[244:247], v[160:163], v[124:127]
  v_mfma_f32_16x16x32_bf16 v[124:127], a[248:251], v[160:163], v[124:127]
  v_mfma_f32_16x16x32_bf16 v[124:127], a[252:255], v[160:163], v[124:127]
Lpoll7:
  s_waitcnt vmcnt(0)
  v_cmp_ne_u64 vcc, s[80:81], v[16:17]
  s_cbranch_vccz Lpolld7
  s_cmp_lg_u32 s82, 32
  s_cbranch_scc1 Lpollp7
  s_add_u32 s83, s59, 0x10000
  s_mov_b64 exec, 1
  buffer_store_dwordx2 v[2:3], off, s[32:35], s83 sc1
  s_mov_b64 exec, -1
Lpollp7:
  s_cmp_lt_u32 s82, 32
  s_cselect_b32 s83, 0, 0x10000
  s_add_u32 s83, s83, s58
  buffer_load_dwordx2 v[16:17], v4, s[32:35], s83 offen sc1
  s_add_u32 s82, s82, 1
  s_cmp_gt_u32 s82, 0x20000
  s_cbranch_scc1 Lend
  s_branch Lpoll7
Lpolld7:
  buffer_load_dwordx2 v[80:81], v0, s[32:35], s67 offen offset:0 sc1
  buffer_load_dwordx2 v[82:83], v0, s[32:35], s67 offen offset:512 sc1
  buffer_load_dwordx2 v[84:85], v0, s[32:35], s67 offen offset:1024 sc1
  buffer_load_dwordx2 v[86:87], v0, s[32:35], s67 offen offset:1536 sc1
  s_add_u32 s93, s65, 0
  buffer_load_dwordx4 v14, s[32:35], s93 offen offset:0 sc1 lds
  buffer_load_dwordx4 v14, s[32:35], s93 offen offset:1024 sc1 lds
  buffer_load_dwordx4 v14, s[32:35], s93 offen offset:2048 sc1 lds
  buffer_load_dwordx4 v14, s[32:35], s93 offen offset:3072 sc1 lds
  s_add_u32 s53, s64, 4096
  s_mov_b32 m0, s53
  s_add_u32 s93, s65, 4096
  buffer_load_dwordx4 v14, s[32:35], s93 offen offset:0 sc1 lds
  buffer_load_dwordx4 v14, s[32:35], s93 offen offset:1024 sc1 lds
  buffer_load_dwordx4 v14, s[32:35], s93 offen offset:2048 sc1 lds
  buffer_load_dwordx4 v14, s[32:35], s93 offen offset:3072 sc1 lds
  v_mfma_f32_16x16x32_bf16 v[116:119], v[192:195], v[160:163], 0
  v_mfma_f32_16x16x32_bf16 v[116:119], v[196:199], v[160:163], v[116:119]
  v_mfma_f32_16x16x32_bf16 v[116:119], v[200:203], v[160:163], v[116:119]
  v_mfma_f32_16x16x32_bf16 v[116:119], v[204:207], v[160:163], v[116:119]
  v_mfma_f32_16x16x32_bf16 v[116:119], v[208:211], v[160:163], v[116:119]
  v_mfma_f32_16x16x32_bf16 v[116:119], v[212:215], v[160:163], v[116:119]
  v_mfma_f32_16x16x32_bf16 v[116:119], v[216:219], v[160:163], v[116:119]
  v_mfma_f32_16x16x32_bf16 v[116:119], v[220:223], v[160:163], v[116:119]
  v_mfma_f32_16x16x32_bf16 v[116:119], v[224:227], v[160:163], v[116:119]
  v_mfma_f32_16x16x32_bf16 v[116:119], v[228:231], v[160:163], v[116:119]
  v_mfma_f32_16x16x32_bf16 v[116:119], v[232:235], v[160:163], v[116:119]
  v_mfma_f32_16x16x32_bf16 v[116:119], v[236:239], v[160:163], v[116:119]
  v_mfma_f32_16x16x32_bf16 v[116:119], v[240:243], v[160:163], v[116:119]
  v_mfma_f32_16x16x32_bf16 v[116:119], v[244:247], v[160:163], v[116:119]
  v_mfma_f32_16x16x32_bf16 v[116:119], v[248:251], v[160:163], v[116:119]
  v_mfma_f32_16x16x32_bf16 v[116:119], v[252:255], v[160:163], v[116:119]
  s_waitcnt vmcnt(8)
  v_pk_add_f32 v[80:81], v[80:81], v[82:83]
  v_pk_add_f32 v[84:85], v[84:85], v[86:87]
  v_pk_add_f32 v[80:81], v[80:81], v[84:85]
  ds_write_b64 v114, v[80:81]
  s_lshl_b32 s53, s48, 10
  s_add_u32 s53, s53, 116736
  v_add_u32 v7, s53, v14
  v_lshl_add_u32 v0, v5, 4, s53
  s_waitcnt vmcnt(0) lgkmcnt(0)
  s_barrier
  ds_read_b128 v[72:75], v115
  ds_read_b128 v[76:79], v115 offset:16
  ds_read_b128 v[40:43], v8 offset:0
  ds_read_b128 v[44:47], v8 offset:2048
  ds_read_b128 v[48:51], v8 offset:4096
  ds_read_b128 v[52:55], v8 offset:6144
  ds_read_b128 v[56:59], v8 offset:8192
  ds_read_b128 v[60:63], v8 offset:10240
  ds_read_b128 v[64:67], v8 offset:12288
  ds_read_b128 v[68:71], v8 offset:14336
  s_waitcnt lgkmcnt(6)
  v_mfma_f32_16x16x32_bf16 v[16:19], v[192:195], v[40:43], 0
  v_mfma_f32_16x16x32_bf16 v[20:23], a[128:131], v[40:43], 0
  v_add_f32 v72, v72, v74
  v_add_f32 v73, v73, v75
  v_mfma_f32_16x16x32_bf16 v[24:27], a[192:195], v[40:43], 0
  v_add_f32 v76, v76, v78
  v_add_f32 v77, v77, v79
  s_add_u32 s53, s64, 32768
  s_mov_b32 m0, s53
  s_add_u32 s93, s65, 32768
  buffer_load_dwordx4 v14, s[32:35], s93 offen offset:0 sc1 lds
  v_mfma_f32_16x16x32_bf16 v[16:19], v[196:199], v[44:47], v[16:19]
  v_add_f32 v72, v72, v76
  v_add_f32 v73, v73, v77
  v_mfma_f32_16x16x32_bf16 v[20:23], a[132:135], v[44:47], v[20:23]
  v_mul_f32 v72, s60, v72
  v_mul_f32 v74, v72, v72
  v_mfma_f32_16x16x32_bf16 v[24:27], a[196:199], v[44:47], v[24:27]
  v_fma_f32 v73, v73, s60, -v74
  v_max_f32 v73, 0, v73
  buffer_load_dwordx4 v14, s[32:35], s93 offen offset:1024 sc1 lds
  ds_read_b128 v[40:43], v8 offset:16384
  ds_read_b128 v[44:47], v8 offset:18432
  s_waitcnt lgkmcnt(6)
  v_mfma_f32_16x16x32_bf16 v[16:19], v[200:203], v[48:51], v[16:19]
  v_add_f32 v73, 0x3727c5ac, v73
  v_mfma_f32_16x16x32_bf16 v[20:23], a[136:139], v[48:51], v[20:23]
  v_rsq_f32 v76, v73
  v_mfma_f32_16x16x32_bf16 v[24:27], a[200:203], v[48:51], v[24:27]
  v_sqrt_f32 v75, v73
  buffer_load_dwordx4 v14, s[32:35], s93 offen offset:2048 sc1 lds
  v_mfma_f32_16x16x32_bf16 v[16:19], v[204:207], v[52:55], v[16:19]
  v_mul_f32 v73, 0xc0135761, v76
  v_mul_f32 v74, v76, v76
  v_mfma_f32_16x16x32_bf16 v[20:23], a[140:143], v[52:55], v[20:23]
  v_mul_f32 v74, v74, v76
  v_mul_f32 v74, 0xbdd2d3e8, v74
  v_mfma_f32_16x16x32_bf16 v[24:27], a[204:207], v[52:55], v[24:27]
  v_sub_f32 v72, 0, v72
  ds_write_b128 v7, v[72:75]
  buffer_load_dwordx4 v14, s[32:35], s93 offen offset:3072 sc1 lds
  ds_read_b128 v[48:51], v8 offset:20480
  ds_read_b128 v[52:55], v8 offset:22528
  s_waitcnt lgkmcnt(7)
  v_mfma_f32_16x16x32_bf16 v[16:19], v[208:211], v[56:59], v[16:19]
  ds_read_b128 v[96:99], v0 offset:0
  ds_read_b128 v[100:103], v0 offset:256
  v_mfma_f32_16x16x32_bf16 v[20:23], a[144:147], v[56:59], v[20:23]
  ds_read_b128 v[104:107], v0 offset:512
  ds_read_b128 v[108:111], v0 offset:768
  v_mfma_f32_16x16x32_bf16 v[24:27], a[208:211], v[56:59], v[24:27]
  s_add_u32 s53, s64, 36864
  s_mov_b32 m0, s53
  s_add_u32 s93, s65, 36864
  buffer_load_dwordx4 v14, s[32:35], s93 offen offset:0 sc1 lds
  v_mfma_f32_16x16x32_bf16 v[16:19], v[212:215], v[60:63], v[16:19]
  v_mfma_f32_16x16x32_bf16 v[20:23], a[148:151], v[60:63], v[20:23]
  v_mfma_f32_16x16x32_bf16 v[24:27], a[212:215], v[60:63], v[24:27]
  buffer_load_dwordx4 v14, s[32:35], s93 offen offset:1024 sc1 lds
  ds_read_b128 v[56:59], v8 offset:24576
  ds_read_b128 v[60:63], v8 offset:26624
  s_waitcnt lgkmcnt(11)
  v_mfma_f32_16x16x32_bf16 v[16:19], v[216:219], v[64:67], v[16:19]
  v_mfma_f32_16x16x32_bf16 v[20:23], a[152:155], v[64:67], v[20:23]
  v_mfma_f32_16x16x32_bf16 v[24:27], a[216:219], v[64:67], v[24:27]
  buffer_load_dwordx4 v14, s[32:35], s93 offen offset:2048 sc1 lds
  v_mfma_f32_16x16x32_bf16 v[16:19], v[220:223], v[68:71], v[16:19]
  v_mfma_f32_16x16x32_bf16 v[20:23], a[156:159], v[68:71], v[20:23]
  v_mfma_f32_16x16x32_bf16 v[24:27], a[220:223], v[68:71], v[24:27]
  buffer_load_dwordx4 v14, s[32:35], s93 offen offset:3072 sc1 lds
  ds_read_b128 v[64:67], v8 offset:28672
  ds_read_b128 v[68:71], v8 offset:30720
  s_waitcnt lgkmcnt(11)
  v_mfma_f32_16x16x32_bf16 v[16:19], v[224:227], v[40:43], v[16:19]
  v_mfma_f32_16x16x32_bf16 v[20:23], a[160:163], v[40:43], v[20:23]
  v_mfma_f32_16x16x32_bf16 v[24:27], a[224:227], v[40:43], v[24:27]
  s_add_u32 s87, s74, 0
  buffer_load_dwordx4 a[0:3], v112, s[36:39], s87 offen offset:0
  v_mfma_f32_16x16x32_bf16 v[16:19], v[228:231], v[44:47], v[16:19]
  v_mfma_f32_16x16x32_bf16 v[20:23], a[164:167], v[44:47], v[20:23]
  v_mfma_f32_16x16x32_bf16 v[24:27], a[228:231], v[44:47], v[24:27]
  buffer_load_dwordx4 a[4:7], v113, s[36:39], s87 offen offset:0
  ds_read_b128 v[40:43], v8 offset:256
  ds_read_b128 v[44:47], v8 offset:2304
  s_waitcnt lgkmcnt(10)
  v_mfma_f32_16x16x32_bf16 v[16:19], v[232:235], v[48:51], v[16:19]
  v_mfma_f32_16x16x32_bf16 v[20:23], a[168:171], v[48:51], v[20:23]
  v_mfma_f32_16x16x32_bf16 v[24:27], a[232:235], v[48:51], v[24:27]
  buffer_load_dwordx4 a[8:11], v112, s[36:39], s87 offen offset:2048
  v_mfma_f32_16x16x32_bf16 v[16:19], v[236:239], v[52:55], v[16:19]
  v_mfma_f32_16x16x32_bf16 v[20:23], a[172:175], v[52:55], v[20:23]
  v_mfma_f32_16x16x32_bf16 v[24:27], a[236:239], v[52:55], v[24:27]
  buffer_load_dwordx4 a[12:15], v113, s[36:39], s87 offen offset:2048
  ds_read_b128 v[48:51], v8 offset:4352
  ds_read_b128 v[52:55], v8 offset:6400
  s_waitcnt lgkmcnt(6)
  v_mfma_f32_16x16x32_bf16 v[16:19], v[240:243], v[56:59], v[16:19]
  v_mfma_f32_16x16x32_bf16 v[20:23], a[176:179], v[56:59], v[20:23]
  v_mfma_f32_16x16x32_bf16 v[24:27], a[240:243], v[56:59], v[24:27]
  s_add_u32 s87, s74, 4096
  buffer_load_dwordx4 a[16:19], v112, s[36:39], s87 offen offset:0
  v_mfma_f32_16x16x32_bf16 v[16:19], v[244:247], v[60:63], v[16:19]
  v_mfma_f32_16x16x32_bf16 v[20:23], a[180:183], v[60:63], v[20:23]
  v_mfma_f32_16x16x32_bf16 v[24:27], a[244:247], v[60:63], v[24:27]
  buffer_load_dwordx4 a[20:23], v113, s[36:39], s87 offen offset:0
  ds_read_b128 v[56:59], v8 offset:8448
  ds_read_b128 v[60:63], v8 offset:10496
  s_waitcnt lgkmcnt(6)
  v_mfma_f32_16x16x32_bf16 v[16:19], v[248:251], v[64:67], v[16:19]
  v_mfma_f32_16x16x32_bf16 v[20:23], a[184:187], v[64:67], v[20:23]
  v_mfma_f32_16x16x32_bf16 v[24:27], a[248:251], v[64:67], v[24:27]
  buffer_load_dwordx4 a[24:27], v112, s[36:39], s87 offen offset:2048
  v_mfma_f32_16x16x32_bf16 v[16:19], v[252:255], v[68:71], v[16:19]
  v_mfma_f32_16x16x32_bf16 v[20:23], a[188:191], v[68:71], v[20:23]
  v_mfma_f32_16x16x32_bf16 v[24:27], a[252:255], v[68:71], v[24:27]
  buffer_load_dwordx4 a[28:31], v113, s[36:39], s87 offen offset:2048
  ds_read_b128 v[64:67], v8 offset:12544
  ds_read_b128 v[68:71], v8 offset:14592
  s_waitcnt lgkmcnt(6)
  v_mfma_f32_16x16x32_bf16 v[28:31], v[192:195], v[40:43], 0
  v_mfma_f32_16x16x32_bf16 v[32:35], a[128:131], v[40:43], 0
  v_mfma_f32_16x16x32_bf16 v[36:39], a[192:195], v[40:43], 0
  s_add_u32 s87, s74, 8192
  buffer_load_dwordx4 a[32:35], v112, s[36:39], s87 offen offset:0
  v_mfma_f32_16x16x32_bf16 v[28:31], v[196:199], v[44:47], v[28:31]
  v_fmac_f32 v16, v96, v116
  v_fmac_f32 v17, v96, v117
  v_fmac_f32 v18, v96, v118
  v_mfma_f32_16x16x32_bf16 v[32:35], a[132:135], v[44:47], v[32:35]
  v_fmac_f32 v19, v96, v119
  v_fmac_f32 v20, v96, v120
  v_fmac_f32 v21, v96, v121
  v_mfma_f32_16x16x32_bf16 v[36:39], a[196:199], v[44:47], v[36:39]
  v_fmac_f32 v22, v96, v122
  v_fmac_f32 v23, v96, v123
  v_fmac_f32 v24, v96, v124
  buffer_load_dwordx4 a[36:39], v113, s[36:39], s87 offen offset:0
  ds_read_b128 v[40:43], v8 offset:16640
  ds_read_b128 v[44:47], v8 offset:18688
  s_waitcnt lgkmcnt(6)
  v_mfma_f32_16x16x32_bf16 v[28:31], v[200:203], v[48:51], v[28:31]
  v_fmac_f32 v25, v96, v125
  v_fmac_f32 v26, v96, v126
  v_fmac_f32 v27, v96, v127
  v_mfma_f32_16x16x32_bf16 v[32:35], a[136:139], v[48:51], v[32:35]
  v_mul_f32 v72, v16, v16
  v_mul_f32 v73, v17, v17
  v_mul_f32 v74, v18, v18
  v_mfma_f32_16x16x32_bf16 v[36:39], a[200:203], v[48:51], v[36:39]
  v_mul_f32 v75, v19, v19
  v_mul_f32 v76, v20, v20
  v_mul_f32 v77, v21, v21
  buffer_load_dwordx4 a[40:43], v112, s[36:39], s87 offen offset:2048
  v_mfma_f32_16x16x32_bf16 v[28:31], v[204:207], v[52:55], v[28:31]
  v_mul_f32 v78, v22, v22
  v_mul_f32 v79, v23, v23
  v_mul_f32 v80, v24, v24
  v_mfma_f32_16x16x32_bf16 v[32:35], a[140:143], v[52:55], v[32:35]
  v_mul_f32 v81, v25, v25
  v_mul_f32 v82, v26, v26
  v_mul_f32 v83, v27, v27
  v_mfma_f32_16x16x32_bf16 v[36:39], a[204:207], v[52:55], v[36:39]
  v_fma_f32 v72, v72, v98, v97
  v_fma_f32 v73, v73, v98, v97
  v_fma_f32 v74, v74, v98, v97
  buffer_load_dwordx4 a[44:47], v113, s[36:39], s87 offen offset:2048
  ds_read_b128 v[48:51], v8 offset:20736
  ds_read_b128 v[52:55], v8 offset:22784
  s_waitcnt lgkmcnt(6)
  v_mfma_f32_16x16x32_bf16 v[28:31], v[208:211], v[56:59], v[28:31]
  v_fma_f32 v75, v75, v98, v97
  v_fma_f32 v76, v76, v98, v97
  v_fma_f32 v77, v77, v98, v97
  v_mfma_f32_16x16x32_bf16 v[32:35], a[144:147], v[56:59], v[32:35]
  v_fma_f32 v78, v78, v98, v97
  v_fma_f32 v79, v79, v98, v97
  v_fma_f32 v80, v80, v98, v97
  v_mfma_f32_16x16x32_bf16 v[36:39], a[208:211], v[56:59], v[36:39]
  v_fma_f32 v81, v81, v98, v97
  v_fma_f32 v82, v82, v98, v97
  v_fma_f32 v83, v83, v98, v97
  s_add_u32 s87, s74, 12288
  buffer_load_dwordx4 a[48:51], v112, s[36:39], s87 offen offset:0
  v_mfma_f32_16x16x32_bf16 v[28:31], v[212:215], v[60:63], v[28:31]
  v_mul_f32 v72, v72, v16
  v_mul_f32 v73, v73, v17
  v_mul_f32 v74, v74, v18
  v_mfma_f32_16x16x32_bf16 v[32:35], a[148:151], v[60:63], v[32:35]
  v_mul_f32 v75, v75, v19
  v_mul_f32 v76, v76, v20
  v_mul_f32 v77, v77, v21
  v_mfma_f32_16x16x32_bf16 v[36:39], a[212:215], v[60:63], v[36:39]
  v_mul_f32 v78, v78, v22
  v_mul_f32 v79, v79, v23
  v_mul_f32 v80, v80, v24
  buffer_load_dwordx4 a[52:55], v113, s[36:39], s87 offen offset:0
  ds_read_b128 v[56:59], v8 offset:24832
  ds_read_b128 v[60:63], v8 offset:26880
  s_waitcnt lgkmcnt(6)
  v_mfma_f32_16x16x32_bf16 v[28:31], v[216:219], v[64:67], v[28:31]
  v_mul_f32 v81, v81, v25
  v_mul_f32 v82, v82, v26
  v_mul_f32 v83, v83, v27
  v_mfma_f32_16x16x32_bf16 v[32:35], a[152:155], v[64:67], v[32:35]
  v_exp_f32 v72, v72
  v_mfma_f32_16x16x32_bf16 v[36:39], a[216:219], v[64:67], v[36:39]
  v_exp_f32 v73, v73
  buffer_load_dwordx4 a[56:59], v112, s[36:39], s87 offen offset:2048
  v_mfma_f32_16x16x32_bf16 v[28:31], v[220:223], v[68:71], v[28:31]
  v_exp_f32 v74, v74
  v_mfma_f32_16x16x32_bf16 v[32:35], a[156:159], v[68:71], v[32:35]
  v_exp_f32 v75, v75
  v_mfma_f32_16x16x32_bf16 v[36:39], a[220:223], v[68:71], v[36:39]
  v_exp_f32 v76, v76
  buffer_load_dwordx4 a[60:63], v113, s[36:39], s87 offen offset:2048
  ds_read_b128 v[64:67], v8 offset:28928
  ds_read_b128 v[68:71], v8 offset:30976
  s_waitcnt lgkmcnt(6)
  v_mfma_f32_16x16x32_bf16 v[28:31], v[224:227], v[40:43], v[28:31]
  v_exp_f32 v77, v77
  v_mfma_f32_16x16x32_bf16 v[32:35], a[160:163], v[40:43], v[32:35]
  v_exp_f32 v78, v78
  v_mfma_f32_16x16x32_bf16 v[36:39], a[224:227], v[40:43], v[36:39]
  v_exp_f32 v79, v79
  s_add_u32 s87, s74, 16384
  buffer_load_dwordx4 a[64:67], v112, s[36:39], s87 offen offset:0
  v_mfma_f32_16x16x32_bf16 v[28:31], v[228:231], v[44:47], v[28:31]
  v_exp_f32 v80, v80
  v_mfma_f32_16x16x32_bf16 v[32:35], a[164:167], v[44:47], v[32:35]
  v_exp_f32 v81, v81
  v_mfma_f32_16x16x32_bf16 v[36:39], a[228:231], v[44:47], v[36:39]
  v_exp_f32 v82, v82
  buffer_load_dwordx4 a[68:71], v113, s[36:39], s87 offen offset:0
  s_waitcnt vmcnt(18)
  s_barrier
  ds_read_b128 v[40:43], v9 offset:0
  ds_read_b128 v[44:47], v9 offset:2048
  s_waitcnt lgkmcnt(6)
  v_mfma_f32_16x16x32_bf16 v[28:31], v[232:235], v[48:51], v[28:31]
  v_exp_f32 v83, v83
  v_fma_f32 v72, v72, v99, v99
  v_fma_f32 v73, v73, v99, v99
  v_mfma_f32_16x16x32_bf16 v[32:35], a[168:171], v[48:51], v[32:35]
  v_fma_f32 v74, v74, v99, v99
  v_fma_f32 v75, v75, v99, v99
  v_fma_f32 v76, v76, v99, v99
  v_fma_f32 v77, v77, v99, v99
  v_mfma_f32_16x16x32_bf16 v[36:39], a[232:235], v[48:51], v[36:39]
  v_fma_f32 v78, v78, v99, v99
  v_fma_f32 v79, v79, v99, v99
  v_fma_f32 v80, v80, v99, v99
  v_fma_f32 v81, v81, v99, v99
  buffer_load_dwordx4 a[72:75], v112, s[36:39], s87 offen offset:2048
  v_mfma_f32_16x16x32_bf16 v[28:31], v[236:239], v[52:55], v[28:31]
  v_fma_f32 v82, v82, v99, v99
  v_fma_f32 v83, v83, v99, v99
  v_mfma_f32_16x16x32_bf16 v[32:35], a[172:175], v[52:55], v[32:35]
  v_rcp_f32 v72, v72
  v_mfma_f32_16x16x32_bf16 v[36:39], a[236:239], v[52:55], v[36:39]
  v_rcp_f32 v73, v73
  buffer_load_dwordx4 a[76:79], v113, s[36:39], s87 offen offset:2048
  ds_read_b128 v[48:51], v9 offset:4096
  ds_read_b128 v[52:55], v9 offset:6144
  s_waitcnt lgkmcnt(6)
  v_mfma_f32_16x16x32_bf16 v[28:31], v[240:243], v[56:59], v[28:31]
  v_rcp_f32 v74, v74
  v_rcp_f32 v75, v75
  v_mfma_f32_16x16x32_bf16 v[32:35], a[176:179], v[56:59], v[32:35]
  v_rcp_f32 v76, v76
  v_rcp_f32 v77, v77
  v_mfma_f32_16x16x32_bf16 v[36:39], a[240:243], v[56:59], v[36:39]
  v_rcp_f32 v78, v78
  v_rcp_f32 v79, v79
  s_add_u32 s87, s74, 20480
  buffer_load_dwordx4 a[80:83], v112, s[36:39], s87 offen offset:0
  v_mfma_f32_16x16x32_bf16 v[28:31], v[244:247], v[60:63], v[28:31]
  v_rcp_f32 v80, v80
  v_mfma_f32_16x16x32_bf16 v[32:35], a[180:183], v[60:63], v[32:35]
  v_rcp_f32 v81, v81
  v_mfma_f32_16x16x32_bf16 v[36:39], a[244:247], v[60:63], v[36:39]
  v_rcp_f32 v82, v82
  buffer_load_dwordx4 a[84:87], v113, s[36:39], s87 offen offset:0
  ds_read_b128 v[56:59], v9 offset:8192
  ds_read_b128 v[60:63], v9 offset:10240
  s_waitcnt lgkmcnt(6)
  v_mfma_f32_16x16x32_bf16 v[28:31], v[248:251], v[64:67], v[28:31]
  v_rcp_f32 v83, v83
  v_mul_f32 v16, v16, v72
  v_mul_f32 v17, v17, v73
  v_mfma_f32_16x16x32_bf16 v[32:35], a[184:187], v[64:67], v[32:35]
  v_mul_f32 v18, v18, v74
  v_mul_f32 v19, v19, v75
  v_mul_f32 v20, v20, v76
  v_mul_f32 v21, v21, v77
  v_mfma_f32_16x16x32_bf16 v[36:39], a[248:251], v[64:67], v[36:39]
  v_mul_f32 v22, v22, v78
  v_mul_f32 v23, v23, v79
  v_mul_f32 v24, v24, v80
  v_mul_f32 v25, v25, v81
  buffer_load_dwordx4 a[88:91], v112, s[36:39], s87 offen offset:2048
  v_mfma_f32_16x16x32_bf16 v[28:31], v[252:255], v[68:71], v[28:31]
  v_mul_f32 v26, v26, v82
  v_mul_f32 v27, v27, v83
  v_cvt_pk_bf16_f32 v84, v16, v17
  v_mfma_f32_16x16x32_bf16 v[32:35], a[188:191], v[68:71], v[32:35]
  v_cvt_pk_bf16_f32 v85, v18, v19
  v_cvt_pk_bf16_f32 v88, v20, v21
  v_cvt_pk_bf16_f32 v89, v22, v23
  v_mfma_f32_16x16x32_bf16 v[36:39], a[252:255], v[68:71], v[36:39]
  v_cvt_pk_bf16_f32 v92, v24, v25
  v_cvt_pk_bf16_f32 v93, v26, v27
  buffer_load_dwordx4 a[92:95], v113, s[36:39], s87 offen offset:2048
  ds_read_b128 v[64:67], v9 offset:12288
  ds_read_b128 v[68:71], v9 offset:14336
  s_waitcnt lgkmcnt(6)
  v_mfma_f32_16x16x32_bf16 v[16:19], v[192:195], v[40:43], 0
  v_mfma_f32_16x16x32_bf16 v[20:23], a[128:131], v[40:43], 0
  v_mfma_f32_16x16x32_bf16 v[24:27], a[192:195], v[40:43], 0
  s_add_u32 s87, s74, 24576
  buffer_load_dwordx4 a[96:99], v112, s[36:39], s87 offen offset:0
  v_mfma_f32_16x16x32_bf16 v[16:19], v[196:199], v[44:47], v[16:19]
  v_fmac_f32 v28, v100, v116
  v_fmac_f32 v29, v100, v117
  v_fmac_f32 v30, v100, v118
  v_mfma_f32_16x16x32_bf16 v[20:23], a[132:135], v[44:47], v[20:23]
  v_fmac_f32 v31, v100, v119
  v_fmac_f32 v32, v100, v120
  v_fmac_f32 v33, v100, v121
  v_mfma_f32_16x16x32_bf16 v[24:27], a[196:199], v[44:47], v[24:27]
  v_fmac_f32 v34, v100, v122
  v_fmac_f32 v35, v100, v123
  v_fmac_f32 v36, v100, v124
  buffer_load_dwordx4 a[100:103], v113, s[36:39], s87 offen offset:0
  ds_read_b128 v[40:43], v9 offset:16384
  ds_read_b128 v[44:47], v9 offset:18432
  s_waitcnt lgkmcnt(6)
  v_mfma_f32_16x16x32_bf16 v[16:19], v[200:203], v[48:51], v[16:19]
  v_fmac_f32 v37, v100, v125
  v_fmac_f32 v38, v100, v126
  v_fmac_f32 v39, v100, v127
  v_mfma_f32_16x16x32_bf16 v[20:23], a[136:139], v[48:51], v[20:23]
  v_mul_f32 v72, v28, v28
  v_mul_f32 v73, v29, v29
  v_mul_f32 v74, v30, v30
  v_mfma_f32_16x16x32_bf16 v[24:27], a[200:203], v[48:51], v[24:27]
  v_mul_f32 v75, v31, v31
  v_mul_f32 v76, v32, v32
  v_mul_f32 v77, v33, v33
  buffer_load_dwordx4 a[104:107], v112, s[36:39], s87 offen offset:2048
  v_mfma_f32_16x16x32_bf16 v[16:19], v[204:207], v[52:55], v[16:19]
  v_mul_f32 v78, v34, v34
  v_mul_f32 v79, v35, v35
  v_mul_f32 v80, v36, v36
  v_mfma_f32_16x16x32_bf16 v[20:23], a[140:143], v[52:55], v[20:23]
  v_mul_f32 v81, v37, v37
  v_mul_f32 v82, v38, v38
  v_mul_f32 v83, v39, v39
  v_mfma_f32_16x16x32_bf16 v[24:27], a[204:207], v[52:55], v[24:27]
  v_fma_f32 v72, v72, v102, v101
  v_fma_f32 v73, v73, v102, v101
  v_fma_f32 v74, v74, v102, v101
  buffer_load_dwordx4 a[108:111], v113, s[36:39], s87 offen offset:2048
  ds_read_b128 v[48:51], v9 offset:20480
  ds_read_b128 v[52:55], v9 offset:22528
  s_waitcnt lgkmcnt(6)
  v_mfma_f32_16x16x32_bf16 v[16:19], v[208:211], v[56:59], v[16:19]
  v_fma_f32 v75, v75, v102, v101
  v_fma_f32 v76, v76, v102, v101
  v_fma_f32 v77, v77, v102, v101
  v_mfma_f32_16x16x32_bf16 v[20:23], a[144:147], v[56:59], v[20:23]
  v_fma_f32 v78, v78, v102, v101
  v_fma_f32 v79, v79, v102, v101
  v_fma_f32 v80, v80, v102, v101
  v_mfma_f32_16x16x32_bf16 v[24:27], a[208:211], v[56:59], v[24:27]
  v_fma_f32 v81, v81, v102, v101
  v_fma_f32 v82, v82, v102, v101
  v_fma_f32 v83, v83, v102, v101
  s_add_u32 s87, s74, 28672
  buffer_load_dwordx4 a[112:115], v112, s[36:39], s87 offen offset:0
  v_mfma_f32_16x16x32_bf16 v[16:19], v[212:215], v[60:63], v[16:19]
  v_mul_f32 v72, v72, v28
  v_mul_f32 v73, v73, v29
  v_mul_f32 v74, v74, v30
  v_mfma_f32_16x16x32_bf16 v[20:23], a[148:151], v[60:63], v[20:23]
  v_mul_f32 v75, v75, v31
  v_mul_f32 v76, v76, v32
  v_mul_f32 v77, v77, v33
  v_mfma_f32_16x16x32_bf16 v[24:27], a[212:215], v[60:63], v[24:27]
  v_mul_f32 v78, v78, v34
  v_mul_f32 v79, v79, v35
  v_mul_f32 v80, v80, v36
  buffer_load_dwordx4 a[116:119], v113, s[36:39], s87 offen offset:0
  ds_read_b128 v[56:59], v9 offset:24576
  ds_read_b128 v[60:63], v9 offset:26624
  s_waitcnt lgkmcnt(6)
  v_mfma_f32_16x16x32_bf16 v[16:19], v[216:219], v[64:67], v[16:19]
  v_mul_f32 v81, v81, v37
  v_mul_f32 v82, v82, v38
  v_mul_f32 v83, v83, v39
  v_mfma_f32_16x16x32_bf16 v[20:23], a[152:155], v[64:67], v[20:23]
  v_exp_f32 v72, v72
  v_mfma_f32_16x16x32_bf16 v[24:27], a[216:219], v[64:67], v[24:27]
  v_exp_f32 v73, v73
  buffer_load_dwordx4 a[120:123], v112, s[36:39], s87 offen offset:2048
  v_mfma_f32_16x16x32_bf16 v[16:19], v[220:223], v[68:71], v[16:19]
  v_exp_f32 v74, v74
  v_exp_f32 v75, v75
  v_mfma_f32_16x16x32_bf16 v[20:23], a[156:159], v[68:71], v[20:23]
  v_exp_f32 v76, v76
  v_exp_f32 v77, v77
  v_mfma_f32_16x16x32_bf16 v[24:27], a[220:223], v[68:71], v[24:27]
  v_exp_f32 v78, v78
  v_exp_f32 v79, v79
  buffer_load_dwordx4 a[124:127], v113, s[36:39], s87 offen offset:2048
  ds_read_b128 v[64:67], v9 offset:28672
  ds_read_b128 v[68:71], v9 offset:30720
  s_waitcnt lgkmcnt(6)
  v_mfma_f32_16x16x32_bf16 v[16:19], v[224:227], v[40:43], v[16:19]
  v_exp_f32 v80, v80
  v_mfma_f32_16x16x32_bf16 v[20:23], a[160:163], v[40:43], v[20:23]
  v_exp_f32 v81, v81
  v_mfma_f32_16x16x32_bf16 v[24:27], a[224:227], v[40:43], v[24:27]
  v_exp_f32 v82, v82
  s_add_u32 s87, s74, 32768
  buffer_load_dwordx4 v[144:147], v112, s[36:39], s87 offen offset:0
  v_mfma_f32_16x16x32_bf16 v[16:19], v[228:231], v[44:47], v[16:19]
  v_exp_f32 v83, v83
  v_fma_f32 v72, v72, v103, v103
  v_fma_f32 v73, v73, v103, v103
  v_mfma_f32_16x16x32_bf16 v[20:23], a[164:167], v[44:47], v[20:23]
  v_fma_f32 v74, v74, v103, v103
  v_fma_f32 v75, v75, v103, v103
  v_fma_f32 v76, v76, v103, v103
  v_fma_f32 v77, v77, v103, v103
  v_mfma_f32_16x16x32_bf16 v[24:27], a[228:231], v[44:47], v[24:27]
  v_fma_f32 v78, v78, v103, v103
  v_fma_f32 v79, v79, v103, v103
  v_fma_f32 v80, v80, v103, v103
  v_fma_f32 v81, v81, v103, v103
  buffer_load_dwordx4 v[148:151], v113, s[36:39], s87 offen offset:0
  ds_read_b128 v[40:43], v9 offset:256
  ds_read_b128 v[44:47], v9 offset:2304
  s_waitcnt lgkmcnt(6)
  v_mfma_f32_16x16x32_bf16 v[16:19], v[232:235], v[48:51], v[16:19]
  v_fma_f32 v82, v82, v103, v103
  v_fma_f32 v83, v83, v103, v103
  v_mfma_f32_16x16x32_bf16 v[20:23], a[168:171], v[48:51], v[20:23]
  v_rcp_f32 v72, v72
  v_mfma_f32_16x16x32_bf16 v[24:27], a[232:235], v[48:51], v[24:27]
  v_rcp_f32 v73, v73
  buffer_load_dwordx4 v[152:155], v112, s[36:39], s87 offen offset:2048
  v_mfma_f32_16x16x32_bf16 v[16:19], v[236:239], v[52:55], v[16:19]
  v_rcp_f32 v74, v74
  v_rcp_f32 v75, v75
  v_mfma_f32_16x16x32_bf16 v[20:23], a[172:175], v[52:55], v[20:23]
  v_rcp_f32 v76, v76
  v_rcp_f32 v77, v77
  v_mfma_f32_16x16x32_bf16 v[24:27], a[236:239], v[52:55], v[24:27]
  v_rcp_f32 v78, v78
  v_rcp_f32 v79, v79
  buffer_load_dwordx4 v[156:159], v113, s[36:39], s87 offen offset:2048
  ds_read_b128 v[48:51], v9 offset:4352
  ds_read_b128 v[52:55], v9 offset:6400
  s_waitcnt lgkmcnt(6)
  v_mfma_f32_16x16x32_bf16 v[16:19], v[240:243], v[56:59], v[16:19]
  v_rcp_f32 v80, v80
  v_mfma_f32_16x16x32_bf16 v[20:23], a[176:179], v[56:59], v[20:23]
  v_rcp_f32 v81, v81
  v_mfma_f32_16x16x32_bf16 v[24:27], a[240:243], v[56:59], v[24:27]
  v_rcp_f32 v82, v82
  s_add_u32 s87, s74, 36864
  buffer_load_dwordx4 v[160:163], v112, s[36:39], s87 offen offset:0
  v_mfma_f32_16x16x32_bf16 v[16:19], v[244:247], v[60:63], v[16:19]
  v_rcp_f32 v83, v83
  v_mul_f32 v28, v28, v72
  v_mul_f32 v29, v29, v73
  v_mfma_f32_16x16x32_bf16 v[20:23], a[180:183], v[60:63], v[20:23]
  v_mul_f32 v30, v30, v74
  v_mul_f32 v31, v31, v75
  v_mul_f32 v32, v32, v76
  v_mul_f32 v33, v33, v77
  v_mfma_f32_16x16x32_bf16 v[24:27], a[244:247], v[60:63], v[24:27]
  v_mul_f32 v34, v34, v78
  v_mul_f32 v35, v35, v79
  v_mul_f32 v36, v36, v80
  v_mul_f32 v37, v37, v81
  buffer_load_dwordx4 v[164:167], v113, s[36:39], s87 offen offset:0
  ds_read_b128 v[56:59], v9 offset:8448
  ds_read_b128 v[60:63], v9 offset:10496
  s_waitcnt lgkmcnt(6)
  v_mfma_f32_16x16x32_bf16 v[16:19], v[248:251], v[64:67], v[16:19]
  v_mul_f32 v38, v38, v82
  v_mul_f32 v39, v39, v83
  v_cvt_pk_bf16_f32 v86, v28, v29
  v_mfma_f32_16x16x32_bf16 v[20:23], a[184:187], v[64:67], v[20:23]
  v_cvt_pk_bf16_f32 v87, v30, v31
  v_cvt_pk_bf16_f32 v90, v32, v33
  v_cvt_pk_bf16_f32 v91, v34, v35
  v_mfma_f32_16x16x32_bf16 v[24:27], a[248:251], v[64:67], v[24:27]
  v_cvt_pk_bf16_f32 v94, v36, v37
  v_cvt_pk_bf16_f32 v95, v38, v39
  v_permlane16_swap_b32 v84, v86
  buffer_load_dwordx4 v[168:171], v112, s[36:39], s87 offen offset:2048
  v_mfma_f32_16x16x32_bf16 v[16:19], v[252:255], v[68:71], v[16:19]
  v_permlane16_swap_b32 v85, v87
  v_permlane16_swap_b32 v88, v90
  v_permlane16_swap_b32 v89, v91
  v_mfma_f32_16x16x32_bf16 v[20:23], a[188:191], v[68:71], v[20:23]
  v_permlane16_swap_b32 v92, v94
  v_permlane16_swap_b32 v93, v95
  buffer_store_dwordx4 v[84:87], v14, s[44:47], s56 offen offset:0 sc1
  v_mfma_f32_16x16x32_bf16 v[24:27], a[252:255], v[68:71], v[24:27]
  buffer_store_dwordx4 v[88:91], v14, s[44:47], s56 offen offset:1024 sc1
  buffer_store_dwordx4 v[92:95], v14, s[44:47], s76 offen offset:2048 sc1
  buffer_load_dwordx4 v[172:175], v113, s[36:39], s87 offen offset:2048
  ds_read_b128 v[64:67], v9 offset:12544
  ds_read_b128 v[68:71], v9 offset:14592
  s_waitcnt lgkmcnt(6)
  v_mfma_f32_16x16x32_bf16 v[28:31], v[192:195], v[40:43], 0
  v_mfma_f32_16x16x32_bf16 v[32:35], a[128:131], v[40:43], 0
  v_mfma_f32_16x16x32_bf16 v[36:39], a[192:195], v[40:43], 0
  s_mov_b32 s87, s75
  buffer_load_dwordx4 v[176:179], v112, s[36:39], s87 offen offset:0
  v_mfma_f32_16x16x32_bf16 v[28:31], v[196:199], v[44:47], v[28:31]
  v_fmac_f32 v16, v104, v116
  v_fmac_f32 v17, v104, v117
  v_fmac_f32 v18, v104, v118
  v_mfma_f32_16x16x32_bf16 v[32:35], a[132:135], v[44:47], v[32:35]
  v_fmac_f32 v19, v104, v119
  v_fmac_f32 v20, v104, v120
  v_fmac_f32 v21, v104, v121
  v_mfma_f32_16x16x32_bf16 v[36:39], a[196:199], v[44:47], v[36:39]
  v_fmac_f32 v22, v104, v122
  v_fmac_f32 v23, v104, v123
  v_fmac_f32 v24, v104, v124
  buffer_load_dwordx4 v[180:183], v113, s[36:39], s87 offen offset:0
  ds_read_b128 v[40:43], v9 offset:16640
  ds_read_b128 v[44:47], v9 offset:18688
  s_waitcnt lgkmcnt(6)
  v_mfma_f32_16x16x32_bf16 v[28:31], v[200:203], v[48:51], v[28:31]
  v_fmac_f32 v25, v104, v125
  v_fmac_f32 v26, v104, v126
  v_fmac_f32 v27, v104, v127
  v_mfma_f32_16x16x32_bf16 v[32:35], a[136:139], v[48:51], v[32:35]
  v_mul_f32 v72, v16, v16
  v_mul_f32 v73, v17, v17
  v_mul_f32 v74, v18, v18
  v_mfma_f32_16x16x32_bf16 v[36:39], a[200:203], v[48:51], v[36:39]
  v_mul_f32 v75, v19, v19
  v_mul_f32 v76, v20, v20
  v_mul_f32 v77, v21, v21
  buffer_load_dwordx4 v[184:187], v112, s[36:39], s87 offen offset:2048
  v_mfma_f32_16x16x32_bf16 v[28:31], v[204:207], v[52:55], v[28:31]
  v_mul_f32 v78, v22, v22
  v_mul_f32 v79, v23, v23
  v_mul_f32 v80, v24, v24
  v_mfma_f32_16x16x32_bf16 v[32:35], a[140:143], v[52:55], v[32:35]
  v_mul_f32 v81, v25, v25
  v_mul_f32 v82, v26, v26
  v_mul_f32 v83, v27, v27
  v_mfma_f32_16x16x32_bf16 v[36:39], a[204:207], v[52:55], v[36:39]
  v_fma_f32 v72, v72, v106, v105
  v_fma_f32 v73, v73, v106, v105
  v_fma_f32 v74, v74, v106, v105
  buffer_load_dwordx4 v[188:191], v113, s[36:39], s87 offen offset:2048
  ds_read_b128 v[48:51], v9 offset:20736
  ds_read_b128 v[52:55], v9 offset:22784
  s_waitcnt lgkmcnt(6)
  v_mfma_f32_16x16x32_bf16 v[28:31], v[208:211], v[56:59], v[28:31]
  v_fma_f32 v75, v75, v106, v105
  v_fma_f32 v76, v76, v106, v105
  v_fma_f32 v77, v77, v106, v105
  v_mfma_f32_16x16x32_bf16 v[32:35], a[144:147], v[56:59], v[32:35]
  v_fma_f32 v78, v78, v106, v105
  v_fma_f32 v79, v79, v106, v105
  v_fma_f32 v80, v80, v106, v105
  v_mfma_f32_16x16x32_bf16 v[36:39], a[208:211], v[56:59], v[36:39]
  v_fma_f32 v81, v81, v106, v105
  v_fma_f32 v82, v82, v106, v105
  v_fma_f32 v83, v83, v106, v105
  v_mfma_f32_16x16x32_bf16 v[28:31], v[212:215], v[60:63], v[28:31]
  v_mul_f32 v72, v72, v16
  v_mul_f32 v73, v73, v17
  v_mul_f32 v74, v74, v18
  v_mfma_f32_16x16x32_bf16 v[32:35], a[148:151], v[60:63], v[32:35]
  v_mul_f32 v75, v75, v19
  v_mul_f32 v76, v76, v20
  v_mul_f32 v77, v77, v21
  v_mfma_f32_16x16x32_bf16 v[36:39], a[212:215], v[60:63], v[36:39]
  v_mul_f32 v78, v78, v22
  v_mul_f32 v79, v79, v23
  v_mul_f32 v80, v80, v24
  ds_read_b128 v[56:59], v9 offset:24832
  ds_read_b128 v[60:63], v9 offset:26880
  s_waitcnt lgkmcnt(6)
  v_mfma_f32_16x16x32_bf16 v[28:31], v[216:219], v[64:67], v[28:31]
  v_mul_f32 v81, v81, v25
  v_mul_f32 v82, v82, v26
  v_mul_f32 v83, v83, v27
  v_mfma_f32_16x16x32_bf16 v[32:35], a[152:155], v[64:67], v[32:35]
  v_exp_f32 v72, v72
  v_mfma_f32_16x16x32_bf16 v[36:39], a[216:219], v[64:67], v[36:39]
  v_exp_f32 v73, v73
  v_mfma_f32_16x16x32_bf16 v[28:31], v[220:223], v[68:71], v[28:31]
  v_exp_f32 v74, v74
  v_mfma_f32_16x16x32_bf16 v[32:35], a[156:159], v[68:71], v[32:35]
  v_exp_f32 v75, v75
  v_mfma_f32_16x16x32_bf16 v[36:39], a[220:223], v[68:71], v[36:39]
  v_exp_f32 v76, v76
  ds_read_b128 v[64:67], v9 offset:28928
  ds_read_b128 v[68:71], v9 offset:30976
  s_waitcnt lgkmcnt(6)
  v_mfma_f32_16x16x32_bf16 v[28:31], v[224:227], v[40:43], v[28:31]
  v_exp_f32 v77, v77
  v_mfma_f32_16x16x32_bf16 v[32:35], a[160:163], v[40:43], v[32:35]
  v_exp_f32 v78, v78
  v_mfma_f32_16x16x32_bf16 v[36:39], a[224:227], v[40:43], v[36:39]
  v_exp_f32 v79, v79
  v_mfma_f32_16x16x32_bf16 v[28:31], v[228:231], v[44:47], v[28:31]
  v_exp_f32 v80, v80
  v_mfma_f32_16x16x32_bf16 v[32:35], a[164:167], v[44:47], v[32:35]
  v_exp_f32 v81, v81
  v_mfma_f32_16x16x32_bf16 v[36:39], a[228:231], v[44:47], v[36:39]
  v_exp_f32 v82, v82
  s_waitcnt lgkmcnt(4)
  v_mfma_f32_16x16x32_bf16 v[28:31], v[232:235], v[48:51], v[28:31]
  v_exp_f32 v83, v83
  v_fma_f32 v72, v72, v107, v107
  v_fma_f32 v73, v73, v107, v107
  v_mfma_f32_16x16x32_bf16 v[32:35], a[168:171], v[48:51], v[32:35]
  v_fma_f32 v74, v74, v107, v107
  v_fma_f32 v75, v75, v107, v107
  v_fma_f32 v76, v76, v107, v107
  v_fma_f32 v77, v77, v107, v107
  v_mfma_f32_16x16x32_bf16 v[36:39], a[232:235], v[48:51], v[36:39]
  v_fma_f32 v78, v78, v107, v107
  v_fma_f32 v79, v79, v107, v107
  v_fma_f32 v80, v80, v107, v107
  v_fma_f32 v81, v81, v107, v107
  v_mfma_f32_16x16x32_bf16 v[28:31], v[236:239], v[52:55], v[28:31]
  v_fma_f32 v82, v82, v107, v107
  v_fma_f32 v83, v83, v107, v107
  v_mfma_f32_16x16x32_bf16 v[32:35], a[172:175], v[52:55], v[32:35]
  v_rcp_f32 v72, v72
  v_mfma_f32_16x16x32_bf16 v[36:39], a[236:239], v[52:55], v[36:39]
  v_rcp_f32 v73, v73
  s_add_u32 s59, s79, 0x1458000
  s_add_u32 s58, s72, 0x1458000
  s_waitcnt vmcnt(5)
  s_barrier
  s_cmp_lg_u32 s48, 0
  s_cbranch_scc1 Lsig8
  s_mov_b64 exec, 1
  buffer_store_dwordx2 v[2:3], off, s[32:35], s59
  s_add_u32 s83, s59, 0x10000
  buffer_store_dwordx2 v[2:3], off, s[32:35], s83 sc1
  s_mov_b64 exec, -1
Lsig8:
  s_waitcnt lgkmcnt(2)
  v_mfma_f32_16x16x32_bf16 v[28:31], v[240:243], v[56:59], v[28:31]
  v_rcp_f32 v74, v74
  v_rcp_f32 v75, v75
  v_mfma_f32_16x16x32_bf16 v[32:35], a[176:179], v[56:59], v[32:35]
  v_rcp_f32 v76, v76
  v_rcp_f32 v77, v77
  v_mfma_f32_16x16x32_bf16 v[36:39], a[240:243], v[56:59], v[36:39]
  v_rcp_f32 v78, v78
  v_rcp_f32 v79, v79
  v_mfma_f32_16x16x32_bf16 v[28:31], v[244:247], v[60:63], v[28:31]
  v_rcp_f32 v80, v80
  v_mfma_f32_16x16x32_bf16 v[32:35], a[180:183], v[60:63], v[32:35]
  v_rcp_f32 v81, v81
  v_mfma_f32_16x16x32_bf16 v[36:39], a[244:247], v[60:63], v[36:39]
  v_rcp_f32 v82, v82
  s_waitcnt lgkmcnt(0)
  v_mfma_f32_16x16x32_bf16 v[28:31], v[248:251], v[64:67], v[28:31]
  v_rcp_f32 v83, v83
  v_mul_f32 v16, v16, v72
  v_mul_f32 v17, v17, v73
  v_mfma_f32_16x16x32_bf16 v[32:35], a[184:187], v[64:67], v[32:35]
  v_mul_f32 v18, v18, v74
  v_mul_f32 v19, v19, v75
  v_mul_f32 v20, v20, v76
  v_mul_f32 v21, v21, v77
  v_mfma_f32_16x16x32_bf16 v[36:39], a[248:251], v[64:67], v[36:39]
  v_mul_f32 v22, v22, v78
  v_mul_f32 v23, v23, v79
  v_mul_f32 v24, v24, v80
  v_mul_f32 v25, v25, v81
  v_mfma_f32_16x16x32_bf16 v[28:31], v[252:255], v[68:71], v[28:31]
  v_mul_f32 v26, v26, v82
  v_mul_f32 v27, v27, v83
  v_cvt_pk_bf16_f32 v84, v16, v17
  v_mfma_f32_16x16x32_bf16 v[32:35], a[188:191], v[68:71], v[32:35]
  v_cvt_pk_bf16_f32 v85, v18, v19
  v_cvt_pk_bf16_f32 v88, v20, v21
  v_cvt_pk_bf16_f32 v89, v22, v23
  v_mfma_f32_16x16x32_bf16 v[36:39], a[252:255], v[68:71], v[36:39]
  v_cvt_pk_bf16_f32 v92, v24, v25
  v_cvt_pk_bf16_f32 v93, v26, v27
  v_pk_fma_f32 v[28:29], v[108:109], v[116:117], v[28:29] op_sel:[0,0,0] op_sel_hi:[0,1,1]
  v_pk_fma_f32 v[30:31], v[108:109], v[118:119], v[30:31] op_sel:[0,0,0] op_sel_hi:[0,1,1]
  v_pk_fma_f32 v[32:33], v[108:109], v[120:121], v[32:33] op_sel:[0,0,0] op_sel_hi:[0,1,1]
  v_pk_fma_f32 v[34:35], v[108:109], v[122:123], v[34:35] op_sel:[0,0,0] op_sel_hi:[0,1,1]
  s_nop 1
  v_pk_fma_f32 v[36:37], v[108:109], v[124:125], v[36:37] op_sel:[0,0,0] op_sel_hi:[0,1,1]
  v_pk_fma_f32 v[38:39], v[108:109], v[126:127], v[38:39] op_sel:[0,0,0] op_sel_hi:[0,1,1]
  v_pk_mul_f32 v[72:73], v[28:29], v[28:29]
  v_pk_mul_f32 v[74:75], v[30:31], v[30:31]
  v_pk_mul_f32 v[76:77], v[32:33], v[32:33]
  v_pk_mul_f32 v[78:79], v[34:35], v[34:35]
  v_pk_mul_f32 v[80:81], v[36:37], v[36:37]
  buffer_load_dwordx2 v[114:115], v4, s[32:35], s58 offen sc1
  v_pk_mul_f32 v[82:83], v[38:39], v[38:39]
  v_pk_fma_f32 v[72:73], v[72:73], v[110:111], v[108:109] op_sel:[0,0,1] op_sel_hi:[1,0,1]
  v_pk_fma_f32 v[74:75], v[74:75], v[110:111], v[108:109] op_sel:[0,0,1] op_sel_hi:[1,0,1]
  v_pk_fma_f32 v[76:77], v[76:77], v[110:111], v[108:109] op_sel:[0,0,1] op_sel_hi:[1,0,1]
  v_pk_fma_f32 v[78:79], v[78:79], v[110:111], v[108:109] op_sel:[0,0,1] op_sel_hi:[1,0,1]
  v_pk_fma_f32 v[80:81], v[80:81], v[110:111], v[108:109] op_sel:[0,0,1] op_sel_hi:[1,0,1]
  v_pk_fma_f32 v[82:83], v[82:83], v[110:111], v[108:109] op_sel:[0,0,1] op_sel_hi:[1,0,1]
  v_pk_mul_f32 v[72:73], v[72:73], v[28:29]
  v_pk_mul_f32 v[74:75], v[74:75], v[30:31]
  v_pk_mul_f32 v[76:77], v[76:77], v[32:33]
  v_pk_mul_f32 v[78:79], v[78:79], v[34:35]
  v_pk_mul_f32 v[80:81], v[80:81], v[36:37]
  v_pk_mul_f32 v[82:83], v[82:83], v[38:39]
  v_exp_f32 v72, v72
  v_exp_f32 v73, v73
  v_exp_f32 v74, v74
  v_exp_f32 v75, v75
  v_exp_f32 v76, v76
  v_exp_f32 v77, v77
  v_exp_f32 v78, v78
  v_exp_f32 v79, v79
  v_exp_f32 v80, v80
  v_exp_f32 v81, v81
  v_exp_f32 v82, v82
  v_exp_f32 v83, v83
  v_pk_fma_f32 v[72:73], v[72:73], v[110:111], v[110:111] op_sel:[0,1,1] op_sel_hi:[1,1,1]
  v_pk_fma_f32 v[74:75], v[74:75], v[110:111], v[110:111] op_sel:[0,1,1] op_sel_hi:[1,1,1]
  v_pk_fma_f32 v[76:77], v[76:77], v[110:111], v[110:111] op_sel:[0,1,1] op_sel_hi:[1,1,1]
  v_pk_fma_f32 v[78:79], v[78:79], v[110:111], v[110:111] op_sel:[0,1,1] op_sel_hi:[1,1,1]
  v_pk_fma_f32 v[80:81], v[80:81], v[110:111], v[110:111] op_sel:[0,1,1] op_sel_hi:[1,1,1]
  v_pk_fma_f32 v[82:83], v[82:83], v[110:111], v[110:111] op_sel:[0,1,1] op_sel_hi:[1,1,1]
  v_rcp_f32 v72, v72
  v_rcp_f32 v73, v73
  v_rcp_f32 v74, v74
  v_rcp_f32 v75, v75
  v_rcp_f32 v76, v76
  v_rcp_f32 v77, v77
  v_rcp_f32 v78, v78
  v_rcp_f32 v79, v79
  v_rcp_f32 v80, v80
  v_rcp_f32 v81, v81
  v_rcp_f32 v82, v82
  v_rcp_f32 v83, v83
  v_pk_mul_f32 v[28:29], v[28:29], v[72:73]
  v_pk_mul_f32 v[30:31], v[30:31], v[74:75]
  v_pk_mul_f32 v[32:33], v[32:33], v[76:77]
  v_pk_mul_f32 v[34:35], v[34:35], v[78:79]
  v_pk_mul_f32 v[36:37], v[36:37], v[80:81]
  v_pk_mul_f32 v[38:39], v[38:39], v[82:83]
  v_cvt_pk_bf16_f32 v86, v28, v29
  v_cvt_pk_bf16_f32 v87, v30, v31
  v_cvt_pk_bf16_f32 v90, v32, v33
  v_cvt_pk_bf16_f32 v91, v34, v35
  v_cvt_pk_bf16_f32 v94, v36, v37
  v_cvt_pk_bf16_f32 v95, v38, v39
  v_permlane16_swap_b32 v84, v86
  v_permlane16_swap_b32 v85, v87
  v_permlane16_swap_b32 v88, v90
  v_permlane16_swap_b32 v89, v91
  v_permlane16_swap_b32 v92, v94
  v_permlane16_swap_b32 v93, v95
  buffer_store_dwordx4 v[84:87], v14, s[44:47], s57 offen offset:0 sc1
  buffer_store_dwordx4 v[88:91], v14, s[44:47], s57 offen offset:1024 sc1
  buffer_store_dwordx4 v[92:95], v14, s[44:47], s77 offen offset:2048 sc1
  s_lshl_b32 s53, s68, 1
  s_mul_i32 s57, s53, 90112
  s_mul_i32 s54, s48, 22528
  s_add_u32 s54, s54, 0xa00000
  s_add_u32 s57, s57, s54
  s_add_u32 s56, s57, 90112
  s_waitcnt vmcnt(3)
  v_cmp_ne_u64 vcc, s[80:81], v[114:115]
  s_cbranch_vccz LfcG0
  s_mov_b32 s82, 0
  buffer_load_dwordx2 v[114:115], v4, s[32:35], s58 offen sc1
Lpoll9:
  s_waitcnt vmcnt(0)
  v_cmp_ne_u64 vcc, s[80:81], v[114:115]
  s_cbranch_vccz Lpolld9
  s_cmp_lg_u32 s82, 32
  s_cbranch_scc1 Lpollp9
  s_add_u32 s83, s59, 0x10000
  s_mov_b64 exec, 1
  buffer_store_dwordx2 v[2:3], off, s[32:35], s83 sc1
  s_mov_b64 exec, -1
Lpollp9:
  s_cmp_lt_u32 s82, 32
  s_cselect_b32 s83, 0, 0x10000
  s_add_u32 s83, s83, s58
  buffer_load_dwordx2 v[114:115], v4, s[32:35], s83 offen sc1
  s_add_u32 s82, s82, 1
  s_cmp_gt_u32 s82, 0x20000
  s_cbranch_scc1 Lend
  s_branch Lpoll9
Lpolld9:
LfcG0:
  s_add_u32 s93, s57, 0
  buffer_load_dwordx4 a[128:131], v14, s[32:35], s93 offen offset:0 sc1
  buffer_load_dwordx4 a[132:135], v14, s[32:35], s93 offen offset:1024 sc1
  buffer_load_dwordx4 a[136:139], v14, s[32:35], s93 offen offset:2048 sc1
  buffer_load_dwordx4 a[140:143], v14, s[32:35], s93 offen offset:3072 sc1
  s_add_u32 s93, s57, 4096
  buffer_load_dwordx4 a[144:147], v14, s[32:35], s93 offen offset:0 sc1
  buffer_load_dwordx4 a[148:151], v14, s[32:35], s93 offen offset:1024 sc1
  buffer_load_dwordx4 a[152:155], v14, s[32:35], s93 offen offset:2048 sc1
  buffer_load_dwordx4 a[156:159], v14, s[32:35], s93 offen offset:3072 sc1
  s_add_u32 s59, s79, 0x1456000
  s_add_u32 s58, s72, 0x1456000
  s_mov_b32 s40, s26
  s_mov_b32 s41, s27
  s_mov_b32 s42, 0x200000
  s_mov_b32 s43, 0x20000
  v_lshlrev_b32 v7, 10, v5
  v_lshrrev_b32 v8, 5, v1
  v_lshl_add_u32 v7, v8, 4, v7
  v_and_b32 v8, 1, v6
  v_lshl_add_u32 v7, v8, 5, v7
  s_lshl_b32 s64, s66, 15
  s_lshr_b32 s54, s70, 5
  s_add_u32 s64, s64, s54
  s_sub_u32 s96, 0, s51
  s_mov_b32 s97, s96
  s_not_b64 s[98:99], s[96:97]
  v_cndmask_b32 v8, v12, v10, s[96:97]
  v_cndmask_b32 v9, v10, v12, s[96:97]
  s_waitcnt vmcnt(8)
  s_barrier
  s_cmp_lg_u32 s48, 0
  s_cbranch_scc1 Lsig10
  s_mov_b64 exec, 1
  buffer_store_dwordx2 v[2:3], off, s[32:35], s59
  s_add_u32 s83, s59, 0x10000
  buffer_store_dwordx2 v[2:3], off, s[32:35], s83 sc1
  s_mov_b64 exec, -1
Lsig10:
  s_waitcnt vmcnt(7)
  v_mfma_f32_32x32x16_bf16 v[16:31], a[0:3], a[128:131], 0
  s_add_u32 s93, s57, 8192
  buffer_load_dwordx4 a[160:163], v14, s[32:35], s93 offen offset:0 sc1
  v_mfma_f32_32x32x16_bf16 v[32:47], a[4:7], a[128:131], 0
  s_waitcnt vmcnt(7)
  v_mfma_f32_32x32x16_bf16 v[16:31], a[8:11], a[132:135], v[16:31]
  buffer_load_dwordx4 a[164:167], v14, s[32:35], s93 offen offset:1024 sc1
  v_mfma_f32_32x32x16_bf16 v[32:47], a[12:15], a[132:135], v[32:47]
  s_waitcnt vmcnt(7)
  v_mfma_f32_32x32x16_bf16 v[16:31], a[16:19], a[136:139], v[16:31]
  buffer_load_dwordx4 a[168:171], v14, s[32:35], s93 offen offset:2048 sc1
  v_mfma_f32_32x32x16_bf16 v[32:47], a[20:23], a[136:139], v[32:47]
  s_waitcnt vmcnt(7)
  v_mfma_f32_32x32x16_bf16 v[16:31], a[24:27], a[140:143], v[16:31]
  buffer_load_dwordx4 a[172:175], v14, s[32:35], s93 offen offset:3072 sc1
  v_mfma_f32_32x32x16_bf16 v[32:47], a[28:31], a[140:143], v[32:47]
  s_waitcnt vmcnt(7)
  v_mfma_f32_32x32x16_bf16 v[16:31], a[32:35], a[144:147], v[16:31]
  s_add_u32 s93, s57, 12288
  buffer_load_dwordx4 a[176:179], v14, s[32:35], s93 offen offset:0 sc1
  v_mfma_f32_32x32x16_bf16 v[32:47], a[36:39], a[144:147], v[32:47]
  s_waitcnt vmcnt(7)
  v_mfma_f32_32x32x16_bf16 v[16:31], a[40:43], a[148:151], v[16:31]
  buffer_load_dwordx4 a[180:183], v14, s[32:35], s93 offen offset:1024 sc1
  v_mfma_f32_32x32x16_bf16 v[32:47], a[44:47], a[148:151], v[32:47]
  s_waitcnt vmcnt(7)
  v_mfma_f32_32x32x16_bf16 v[16:31], a[48:51], a[152:155], v[16:31]
  buffer_load_dwordx4 a[184:187], v14, s[32:35], s93 offen offset:2048 sc1
  v_mfma_f32_32x32x16_bf16 v[32:47], a[52:55], a[152:155], v[32:47]
  s_waitcnt vmcnt(7)
  v_mfma_f32_32x32x16_bf16 v[16:31], a[56:59], a[156:159], v[16:31]
  buffer_load_dwordx4 a[188:191], v14, s[32:35], s93 offen offset:3072 sc1
  v_mfma_f32_32x32x16_bf16 v[32:47], a[60:63], a[156:159], v[32:47]
  s_waitcnt vmcnt(7)
  buffer_load_dwordx2 v[114:115], v4, s[32:35], s58 offen sc1
  v_mfma_f32_32x32x16_bf16 v[16:31], a[64:67], a[160:163], v[16:31]
  s_add_u32 s93, s57, 16384
  buffer_load_dwordx4 a[192:195], v14, s[32:35], s93 offen offset:0 sc1
  v_mfma_f32_32x32x16_bf16 v[32:47], a[68:71], a[160:163], v[32:47]
  s_waitcnt vmcnt(8)
  v_mfma_f32_32x32x16_bf16 v[16:31], a[72:75], a[164:167], v[16:31]
  buffer_load_dwordx4 a[196:199], v14, s[32:35], s93 offen offset:1024 sc1
  v_mfma_f32_32x32x16_bf16 v[32:47], a[76:79], a[164:167], v[32:47]
  s_waitcnt vmcnt(8)
  v_mfma_f32_32x32x16_bf16 v[16:31], a[80:83], a[168:171], v[16:31]
  buffer_load_dwordx4 a[200:203], v14, s[32:35], s93 offen offset:2048 sc1
  v_mfma_f32_32x32x16_bf16 v[32:47], a[84:87], a[168:171], v[32:47]
  s_waitcnt vmcnt(8)
  v_mfma_f32_32x32x16_bf16 v[16:31], a[88:91], a[172:175], v[16:31]
  buffer_load_dwordx4 a[204:207], v14, s[32:35], s93 offen offset:3072 sc1
  v_mfma_f32_32x32x16_bf16 v[32:47], a[92:95], a[172:175], v[32:47]
  s_waitcnt vmcnt(8)
  v_mfma_f32_32x32x16_bf16 v[16:31], a[96:99], a[176:179], v[16:31]
  s_add_u32 s93, s57, 20480
  buffer_load_dwordx4 a[208:211], v14, s[32:35], s93 offen offset:0 sc1
  v_mfma_f32_32x32x16_bf16 v[32:47], a[100:103], a[176:179], v[32:47]
  s_waitcnt vmcnt(8)
  s_waitcnt vmcnt(5)
  v_cmp_ne_u64 vcc, s[80:81], v[114:115]
  s_cbranch_vccz LfcF1
  s_mov_b32 s82, 0
  buffer_load_dwordx2 v[114:115], v4, s[32:35], s58 offen sc1
Lpoll11:
  s_waitcnt vmcnt(0)
  v_cmp_ne_u64 vcc, s[80:81], v[114:115]
  s_cbranch_vccz Lpolld11
  s_cmp_lg_u32 s82, 32
  s_cbranch_scc1 Lpollp11
  s_add_u32 s83, s59, 0x10000
  s_mov_b64 exec, 1
  buffer_store_dwordx2 v[2:3], off, s[32:35], s83 sc1
  s_mov_b64 exec, -1
Lpollp11:
  s_cmp_lt_u32 s82, 32
  s_cselect_b32 s83, 0, 0x10000
  s_add_u32 s83, s83, s58
  buffer_load_dwordx2 v[114:115], v4, s[32:35], s83 offen sc1
  s_add_u32 s82, s82, 1
  s_cmp_gt_u32 s82, 0x20000
  s_cbranch_scc1 Lend
  s_branch Lpoll11
Lpolld11:
LfcF1:
  v_mfma_f32_32x32x16_bf16 v[16:31], a[104:107], a[180:183], v[16:31]
  buffer_load_dwordx4 a[212:215], v14, s[32:35], s93 offen offset:1024 sc1
  v_mfma_f32_32x32x16_bf16 v[32:47], a[108:111], a[180:183], v[32:47]
  v_mfma_f32_32x32x16_bf16 v[16:31], a[112:115], a[184:187], v[16:31]
  s_add_u32 s93, s56, 0
  buffer_load_dwordx4 a[216:219], v14, s[32:35], s93 offen offset:0 sc1
  v_mfma_f32_32x32x16_bf16 v[32:47], a[116:119], a[184:187], v[32:47]
  v_mfma_f32_32x32x16_bf16 v[16:31], a[120:123], a[188:191], v[16:31]
  buffer_load_dwordx4 a[220:223], v14, s[32:35], s93 offen offset:1024 sc1
  v_mfma_f32_32x32x16_bf16 v[32:47], a[124:127], a[188:191], v[32:47]
  s_waitcnt vmcnt(7)
  v_mfma_f32_32x32x16_bf16 v[16:31], v[144:147], a[192:195], v[16:31]
  buffer_load_dwordx4 a[224:227], v14, s[32:35], s93 offen offset:2048 sc1
  v_mfma_f32_32x32x16_bf16 v[32:47], v[148:151], a[192:195], v[32:47]
  s_waitcnt vmcnt(7)
  v_mfma_f32_32x32x16_bf16 v[16:31], v[152:155], a[196:199], v[16:31]
  buffer_load_dwordx4 a[228:231], v14, s[32:35], s93 offen offset:3072 sc1
  v_mfma_f32_32x32x16_bf16 v[32:47], v[156:159], a[196:199], v[32:47]
  s_waitcnt vmcnt(7)
  v_mfma_f32_32x32x16_bf16 v[16:31], v[160:163], a[200:203], v[16:31]
  s_add_u32 s93, s56, 4096
  buffer_load_dwordx4 a[232:235], v14, s[32:35], s93 offen offset:0 sc1
  v_mfma_f32_32x32x16_bf16 v[32:47], v[164:167], a[200:203], v[32:47]
  s_waitcnt vmcnt(7)
  v_mfma_f32_32x32x16_bf16 v[16:31], v[168:171], a[204:207], v[16:31]
  buffer_load_dwordx4 a[236:239], v14, s[32:35], s93 offen offset:1024 sc1
  v_mfma_f32_32x32x16_bf16 v[32:47], v[172:175], a[204:207], v[32:47]
  s_waitcnt vmcnt(7)
  v_mfma_f32_32x32x16_bf16 v[16:31], v[176:179], a[208:211], v[16:31]
  buffer_load_dwordx4 a[240:243], v14, s[32:35], s93 offen offset:2048 sc1
  v_mfma_f32_32x32x16_bf16 v[32:47], v[180:183], a[208:211], v[32:47]
  s_waitcnt vmcnt(7)
  v_mfma_f32_32x32x16_bf16 v[16:31], v[184:187], a[212:215], v[16:31]
  buffer_load_dwordx4 a[244:247], v14, s[32:35], s93 offen offset:3072 sc1
  v_mfma_f32_32x32x16_bf16 v[32:47], v[188:191], a[212:215], v[32:47]
  s_waitcnt vmcnt(7)
  v_mfma_f32_32x32x16_bf16 v[48:63], a[0:3], a[216:219], 0
  s_add_u32 s93, s56, 8192
  buffer_load_dwordx4 a[248:251], v14, s[32:35], s93 offen offset:0 sc1
  v_mfma_f32_32x32x16_bf16 v[64:79], a[4:7], a[216:219], 0
  s_waitcnt vmcnt(7)
  v_mfma_f32_32x32x16_bf16 v[48:63], a[8:11], a[220:223], v[48:63]
  buffer_load_dwordx4 a[252:255], v14, s[32:35], s93 offen offset:1024 sc1
  v_mfma_f32_32x32x16_bf16 v[64:79], a[12:15], a[220:223], v[64:79]
  s_nop 0
  ds_write_b128 v8, v[16:19] offset:0
  s_waitcnt vmcnt(7)
  v_mfma_f32_32x32x16_bf16 v[48:63], a[16:19], a[224:227], v[48:63]
  buffer_load_dwordx4 v[192:195], v14, s[32:35], s93 offen offset:2048 sc1
  v_mfma_f32_32x32x16_bf16 v[64:79], a[20:23], a[224:227], v[64:79]
  ds_write_b128 v8, v[20:23] offset:1024
  s_waitcnt vmcnt(7)
  v_mfma_f32_32x32x16_bf16 v[48:63], a[24:27], a[228:231], v[48:63]
  buffer_load_dwordx4 v[196:199], v14, s[32:35], s93 offen offset:3072 sc1
  v_mfma_f32_32x32x16_bf16 v[64:79], a[28:31], a[228:231], v[64:79]
  ds_write_b128 v8, v[24:27] offset:2048
  s_waitcnt vmcnt(7)
  v_mfma_f32_32x32x16_bf16 v[48:63], a[32:35], a[232:235], v[48:63]
  s_add_u32 s93, s56, 12288
  buffer_load_dwordx4 v[200:203], v14, s[32:35], s93 offen offset:0 sc1
  v_mfma_f32_32x32x16_bf16 v[64:79], a[36:39], a[232:235], v[64:79]
  ds_write_b128 v8, v[28:31] offset:3072
  s_waitcnt vmcnt(7)
  v_mfma_f32_32x32x16_bf16 v[48:63], a[40:43], a[236:239], v[48:63]
  buffer_load_dwordx4 v[204:207], v14, s[32:35], s93 offen offset:1024 sc1
  v_mfma_f32_32x32x16_bf16 v[64:79], a[44:47], a[236:239], v[64:79]
  s_mov_b64 exec, s[96:97]
  ds_write_b128 v11, v[32:35] offset:0
  s_mov_b64 exec, -1
  s_waitcnt vmcnt(7)
  v_mfma_f32_32x32x16_bf16 v[48:63], a[48:51], a[240:243], v[48:63]
  buffer_load_dwordx4 v[208:211], v14, s[32:35], s93 offen offset:2048 sc1
  v_mfma_f32_32x32x16_bf16 v[64:79], a[52:55], a[240:243], v[64:79]
  s_mov_b64 exec, s[96:97]
  ds_write_b128 v11, v[36:39] offset:1024
  s_mov_b64 exec, -1
  s_waitcnt vmcnt(7)
  v_mfma_f32_32x32x16_bf16 v[48:63], a[56:59], a[244:247], v[48:63]
  buffer_load_dwordx4 v[212:215], v14, s[32:35], s93 offen offset:3072 sc1
  v_mfma_f32_32x32x16_bf16 v[64:79], a[60:63], a[244:247], v[64:79]
  s_mov_b64 exec, s[96:97]
  ds_write_b128 v11, v[40:43] offset:2048
  s_mov_b64 exec, -1
  s_waitcnt vmcnt(7)
  v_mfma_f32_32x32x16_bf16 v[48:63], a[64:67], a[248:251], v[48:63]
  s_add_u32 s93, s56, 16384
  buffer_load_dwordx4 v[216:219], v14, s[32:35], s93 offen offset:0 sc1
  v_mfma_f32_32x32x16_bf16 v[64:79], a[68:71], a[248:251], v[64:79]
  s_mov_b64 exec, s[96:97]
  ds_write_b128 v11, v[44:47] offset:3072
  s_mov_b64 exec, -1
  s_waitcnt vmcnt(7)
  v_mfma_f32_32x32x16_bf16 v[48:63], a[72:75], a[252:255], v[48:63]
  buffer_load_dwordx4 v[220:223], v14, s[32:35], s93 offen offset:1024 sc1
  v_mfma_f32_32x32x16_bf16 v[64:79], a[76:79], a[252:255], v[64:79]
  s_waitcnt vmcnt(7)
  v_mfma_f32_32x32x16_bf16 v[48:63], a[80:83], v[192:195], v[48:63]
  buffer_load_dwordx4 v[224:227], v14, s[32:35], s93 offen offset:2048 sc1
  v_mfma_f32_32x32x16_bf16 v[64:79], a[84:87], v[192:195], v[64:79]
  s_waitcnt vmcnt(7)
  v_mfma_f32_32x32x16_bf16 v[48:63], a[88:91], v[196:199], v[48:63]
  buffer_load_dwordx4 v[228:231], v14, s[32:35], s93 offen offset:3072 sc1
  v_mfma_f32_32x32x16_bf16 v[64:79], a[92:95], v[196:199], v[64:79]
  s_waitcnt vmcnt(7)
  v_mfma_f32_32x32x16_bf16 v[48:63], a[96:99], v[200:203], v[48:63]
  s_add_u32 s93, s56, 20480
  buffer_load_dwordx4 v[232:235], v14, s[32:35], s93 offen offset:0 sc1
  v_mfma_f32_32x32x16_bf16 v[64:79], a[100:103], v[200:203], v[64:79]
  s_waitcnt vmcnt(7)
  v_mfma_f32_32x32x16_bf16 v[48:63], a[104:107], v[204:207], v[48:63]
  buffer_load_dwordx4 v[236:239], v14, s[32:35], s93 offen offset:1024 sc1
  v_mfma_f32_32x32x16_bf16 v[64:79], a[108:111], v[204:207], v[64:79]
  s_waitcnt vmcnt(7)
  v_mfma_f32_32x32x16_bf16 v[48:63], a[112:115], v[208:211], v[48:63]
  v_mfma_f32_32x32x16_bf16 v[64:79], a[116:119], v[208:211], v[64:79]
  s_waitcnt vmcnt(6)
  v_mfma_f32_32x32x16_bf16 v[48:63], a[120:123], v[212:215], v[48:63]
  v_mfma_f32_32x32x16_bf16 v[64:79], a[124:127], v[212:215], v[64:79]
  s_waitcnt vmcnt(5)
  v_mfma_f32_32x32x16_bf16 v[48:63], v[144:147], v[216:219], v[48:63]
  v_mfma_f32_32x32x16_bf16 v[64:79], v[148:151], v[216:219], v[64:79]
  s_waitcnt vmcnt(4)
  v_mfma_f32_32x32x16_bf16 v[48:63], v[152:155], v[220:223], v[48:63]
  v_mfma_f32_32x32x16_bf16 v[64:79], v[156:159], v[220:223], v[64:79]
  s_waitcnt vmcnt(3)
  v_mfma_f32_32x32x16_bf16 v[48:63], v[160:163], v[224:227], v[48:63]
  v_mfma_f32_32x32x16_bf16 v[64:79], v[164:167], v[224:227], v[64:79]
  s_waitcnt vmcnt(2)
  v_mfma_f32_32x32x16_bf16 v[48:63], v[168:171], v[228:231], v[48:63]
  v_mfma_f32_32x32x16_bf16 v[64:79], v[172:175], v[228:231], v[64:79]
  s_waitcnt vmcnt(1)
  v_mfma_f32_32x32x16_bf16 v[48:63], v[176:179], v[232:235], v[48:63]
  v_mfma_f32_32x32x16_bf16 v[64:79], v[180:183], v[232:235], v[64:79]
  s_waitcnt vmcnt(0)
  v_mfma_f32_32x32x16_bf16 v[48:63], v[184:187], v[236:239], v[48:63]
  v_mfma_f32_32x32x16_bf16 v[64:79], v[188:191], v[236:239], v[64:79]
  s_nop 10
  ds_write_b128 v9, v[48:51] offset:0
  ds_write_b128 v9, v[52:55] offset:1024
  ds_write_b128 v9, v[56:59] offset:2048
  ds_write_b128 v9, v[60:63] offset:3072
  s_mov_b64 exec, s[98:99]
  ds_write_b128 v11, v[64:67] offset:0
  s_mov_b64 exec, -1
  s_mov_b64 exec, s[98:99]
  ds_write_b128 v11, v[68:71] offset:1024
  s_mov_b64 exec, -1
  s_mov_b64 exec, s[98:99]
  ds_write_b128 v11, v[72:75] offset:2048
  s_mov_b64 exec, -1
  s_mov_b64 exec, s[98:99]
  ds_write_b128 v11, v[76:79] offset:3072
  s_mov_b64 exec, -1
  s_waitcnt lgkmcnt(0)
  s_barrier
  ds_read_b128 v[80:83], v13 offset:0
  ds_read_b128 v[84:87], v13 offset:1024
  ds_read_b128 v[88:91], v13 offset:2048
  ds_read_b128 v[92:95], v13 offset:3072
  ds_read_b128 v[96:99], v13 offset:4096
  ds_read_b128 v[100:103], v13 offset:5120
  ds_read_b128 v[104:107], v13 offset:6144
  ds_read_b128 v[108:111], v13 offset:7168
  ds_read_b128 v[112:115], v13 offset:8192
  ds_read_b128 v[116:119], v13 offset:9216
  ds_read_b128 v[120:123], v13 offset:10240
  ds_read_b128 v[124:127], v13 offset:11264
  s_cmp_eq_u32 s51, 0
  s_cbranch_scc1 Lg40
  v_pk_add_f32 v[64:65], v[64:65], v[128:129]
  v_pk_add_f32 v[66:67], v[66:67], v[130:131]
  v_pk_add_f32 v[68:69], v[68:69], v[132:133]
  v_pk_add_f32 v[70:71], v[70:71], v[134:135]
  v_pk_add_f32 v[72:73], v[72:73], v[136:137]
  v_pk_add_f32 v[74:75], v[74:75], v[138:139]
  v_pk_add_f32 v[76:77], v[76:77], v[140:141]
  v_pk_add_f32 v[78:79], v[78:79], v[142:143]
  s_branch Lg41
Lg40:
  v_pk_add_f32 v[64:65], v[32:33], v[128:129]
  v_pk_add_f32 v[66:67], v[34:35], v[130:131]
  v_pk_add_f32 v[68:69], v[36:37], v[132:133]
  v_pk_add_f32 v[70:71], v[38:39], v[134:135]
  v_pk_add_f32 v[72:73], v[40:41], v[136:137]
  v_pk_add_f32 v[74:75], v[42:43], v[138:139]
  v_pk_add_f32 v[76:77], v[44:45], v[140:141]
  v_pk_add_f32 v[78:79], v[46:47], v[142:143]
Lg41:
  s_waitcnt lgkmcnt(10)
  v_pk_add_f32 v[64:65], v[64:65], v[80:81]
  v_pk_add_f32 v[66:67], v[66:67], v[82:83]
  v_pk_add_f32 v[68:69], v[68:69], v[84:85]
  v_pk_add_f32 v[70:71], v[70:71], v[86:87]
  s_waitcnt lgkmcnt(8)
  v_pk_add_f32 v[72:73], v[72:73], v[88:89]
  v_pk_add_f32 v[74:75], v[74:75], v[90:91]
  v_pk_add_f32 v[76:77], v[76:77], v[92:93]
  v_pk_add_f32 v[78:79], v[78:79], v[94:95]
  s_waitcnt lgkmcnt(6)
  v_pk_add_f32 v[64:65], v[64:65], v[96:97]
  v_pk_add_f32 v[66:67], v[66:67], v[98:99]
  v_pk_add_f32 v[68:69], v[68:69], v[100:101]
  v_pk_add_f32 v[70:71], v[70:71], v[102:103]
  s_waitcnt lgkmcnt(4)
  v_pk_add_f32 v[72:73], v[72:73], v[104:105]
  v_pk_add_f32 v[74:75], v[74:75], v[106:107]
  v_pk_add_f32 v[76:77], v[76:77], v[108:109]
  v_pk_add_f32 v[78:79], v[78:79], v[110:111]
  s_waitcnt lgkmcnt(2)
  v_pk_add_f32 v[64:65], v[64:65], v[112:113]
  v_pk_add_f32 v[66:67], v[66:67], v[114:115]
  v_pk_add_f32 v[68:69], v[68:69], v[116:117]
  v_pk_add_f32 v[70:71], v[70:71], v[118:119]
  s_waitcnt lgkmcnt(0)
  v_pk_add_f32 v[72:73], v[72:73], v[120:121]
  v_pk_add_f32 v[74:75], v[74:75], v[122:123]
  v_pk_add_f32 v[76:77], v[76:77], v[124:125]
  v_pk_add_f32 v[78:79], v[78:79], v[126:127]
  v_cvt_pk_bf16_f32 v96, v64, v65
  v_cvt_pk_bf16_f32 v97, v66, v67
  v_cvt_pk_bf16_f32 v98, v68, v69
  v_cvt_pk_bf16_f32 v99, v70, v71
  v_cvt_pk_bf16_f32 v100, v72, v73
  v_cvt_pk_bf16_f32 v101, v74, v75
  v_cvt_pk_bf16_f32 v102, v76, v77
  v_cvt_pk_bf16_f32 v103, v78, v79
  s_add_u32 s65, s64, 0x4000
  v_permlane16_swap_b32 v96, v100
  v_permlane16_swap_b32 v97, v101
  v_permlane16_swap_b32 v98, v102
  v_permlane16_swap_b32 v99, v103
  buffer_store_dwordx4 v[96:99], v7, s[40:43], s64 offen
  buffer_store_dwordx4 v[100:103], v7, s[40:43], s65 offen
Lend:
  s_endpgm
.fill 4096, 4, 0xbf810000
.section .rodata,"a"
.p2align 6
.amdhsa_kernel sequential_preLN__ssm_conv_h3__mixer_s_mlp__prompt_kernel
  .amdhsa_next_free_vgpr 512
  .amdhsa_next_free_sgpr 102
  .amdhsa_accum_offset 256
  .amdhsa_group_segment_fixed_size 0
  .amdhsa_kernarg_size 112
  .amdhsa_user_sgpr_count 2
  .amdhsa_user_sgpr_kernarg_segment_ptr 1
  .amdhsa_system_sgpr_workgroup_id_x 1
  .amdhsa_float_denorm_mode_32 3
.end_amdhsa_kernel
```
